```python
import torch

def _softmax(x, axis=-1):
    return torch.softmax(x, dim=axis)
def _gelu(x):
    return torch.nn.functional.gelu(x, approximate="tanh")
def _silu(x):
    return torch.nn.functional.silu(x)
def _sigmoid(x):
    return torch.sigmoid(x)
def _layernorm(x, axis=-1, eps=1e-5):
    m = x.mean(dim=axis, keepdim=True)
    v = x.var(dim=axis, keepdim=True, unbiased=False)
    return (x - m) / torch.sqrt(v + eps)
def _scatter_add(tgt, idx, src, axis=0):
    return tgt.clone().index_add_(axis, idx, src)
def _segment_sum(src, seg, n):
    out = torch.zeros((n,) + src.shape[1:], dtype=src.dtype)
    return out.index_add_(0, seg, src)
def _pad(x, pw):
    flat = tuple(v for pair in reversed(pw) for v in pair)
    return torch.nn.functional.pad(x, flat)

kernel_name = 'gated_mix__spectral_gfnet__dense_activation_silu__prompt'

def setup_inputs():

    _w = (lambda a: (lambda t: t.to(torch.bfloat16) if t.is_floating_point() else t)(torch.as_tensor(a)))
    def _A_setup():
        B, S, D = 1, 2048, 1024
        Df = D // 2 + 1
        return {
            "x": _w((lambda *s: torch.randn(*s, dtype=torch.bfloat16) * 0.05)(B, S, D)),
            "w_r": _w((lambda *s: torch.randn(*s, dtype=torch.bfloat16) * 0.8)(S, Df) * 0.02),
            "w_i": _w((lambda *s: torch.randn(*s, dtype=torch.bfloat16) * 0.8)(S, Df) * 0.02),
        }
    _A_in = _A_setup()

    def _B_setup():
        B, S, D, F = 1, 2048, 1024, 3584
        return {
            "x": _w((lambda *s: torch.randn(*s, dtype=torch.bfloat16) * 0.05)(B, S, D)),
            "w1": _w((lambda *s: torch.randn(*s, dtype=torch.bfloat16) * 3.2)(D, F) * (D ** -0.5)),
            "w2": _w((lambda *s: torch.randn(*s, dtype=torch.bfloat16) * 0.05)(F, D) * (F ** -0.5)),
        }
    _B_in = _B_setup()

    return {
        "A_x": _A_in["x"],
        "A_w_r": _A_in["w_r"],
        "A_w_i": _A_in["w_i"],
        "B_x": _B_in["x"],
        "B_w1": _B_in["w1"],
        "B_w2": _B_in["w2"],
        "gate_w": _w((lambda *s: torch.randn(*s, dtype=torch.bfloat16) * 0.05)(1024) * 16.0),
    }

def reference(A_x, A_w_r, A_w_i, B_x, B_w1, B_w2, gate_w):
    def _A_ref(x, w_r, w_i):
        B, S, D = x.shape
        X = (lambda x, axes=(-2,-1): torch.fft.rfft2(x.float(), dim=axes))(x, axes=(-2, -1))
        W = w_r + 1j * w_i
        X = X * W
        y = (lambda x, s, axes=(-2,-1): torch.fft.irfft2(x, s=s, dim=axes).to(torch.bfloat16))(X, (S, D), axes=(-2, -1))
        return y

    def _B_ref(x, w1, w2):
        h = torch.einsum("bsd,df->bsf", x, w1)
        h = _silu(h)
        out = torch.einsum("bsf,fd->bsd", h, w2)
        return out

    x = A_x
    g = _sigmoid((x * gate_w).sum(-1, keepdims=True))
    a = _A_ref(x, A_w_r, A_w_i)
    b = _B_ref(x, B_w1, B_w2)
    return g * a + (1 - g) * b
```

```asm
; @launch grid=(256,1,1) block=(512,1,1) lds=163840
.amdgcn_target "amdgcn-amd-amdhsa--gfx950"
.text
.globl gated_mix__spectral_gfnet__dense_activation_silu__prompt_kernel
.p2align 8
.type gated_mix__spectral_gfnet__dense_activation_silu__prompt_kernel,@function
gated_mix__spectral_gfnet__dense_activation_silu__prompt_kernel:
    s_cmp_ge_u32 s2, 256
    s_cbranch_scc1 F_end
    s_load_dwordx2 s[4:5], s[0:1], 0
    s_load_dwordx2 s[6:7], s[0:1], 32
    s_load_dwordx2 s[8:9], s[0:1], 72
    v_lshrrev_b32 v1, 6, v0
    v_and_b32 v2, 63, v0
    v_readfirstlane_b32 s31, v1
    s_and_b32 s20, s2, 7
    s_lshr_b32 s21, s2, 3
    s_sub_u32 s30, s31, 4
    s_cmp_ge_u32 s31, 4
    s_cbranch_scc1 cpsk_1
    s_mul_i32 s92, s21, 4
    s_add_u32 s92, s92, s31
    s_lshl_b32 s92, s92, 10
    s_cmp_ge_u32 s92, (TEXT_END-gated_mix__spectral_gfnet__dense_activation_silu__prompt_kernel)-1023
    s_cbranch_scc1 CP_2
    s_getpc_b64 s[90:91]
CPpc_3:
    s_sub_u32 s90, s90, CPpc_3-gated_mix__spectral_gfnet__dense_activation_silu__prompt_kernel
    s_subb_u32 s91, s91, 0
    v_lshlrev_b32 v116, 4, v2
    v_add_u32 v116, s92, v116
    global_load_dwordx4 v[116:119], v116, s[90:91]
CP_2:
cpsk_1:
    s_cmp_ge_u32 s21, 28
    s_cbranch_scc1 F_fft0
    s_and_b32 s22, s20, 1
    s_lshl_b32 s22, s22, 2
    s_and_b32 s23, s21, 3
    s_add_u32 s22, s22, s23
    s_lshr_b32 s23, s20, 1
    s_mul_i32 s23, s23, 7
    s_lshr_b32 s24, s21, 2
    s_add_u32 s23, s23, s24
    s_cmp_lt_u32 s31, 4
    s_cbranch_scc1 F_g1cons
F_g1load:
    s_lshl_b32 s28, s22, 16
    s_lshl_b32 s29, s23, 8
    v_lshrrev_b32 v12, 3, v2
    s_and_b32 s40, s30, 1
    s_lshl_b32 s40, s40, 3
    s_lshr_b32 s41, s30, 1
    s_lshl_b32 s41, s41, 8
    s_add_u32 s40, s40, s41
    v_add_u32 v12, s40, v12
    v_lshlrev_b32 v12, 11, v12
    v_lshrrev_b32 v13, 4, v2
    s_and_b32 s40, s30, 1
    s_lshl_b32 s40, s40, 2
    v_add_u32 v13, s40, v13
    v_and_b32 v10, 7, v2
    v_xor_b32 v13, v13, v10
    v_lshlrev_b32 v13, 4, v13
    v_add_u32 v10, v12, v13
    v_lshrrev_b32 v12, 4, v2
    s_lshr_b32 s40, s30, 1
    s_and_b32 s40, s40, 1
    s_lshl_b32 s40, s40, 2
    v_or_b32 v13, s40, v12
    s_lshl_b32 s41, s30, 2
    v_add_u32 v12, s41, v12
    s_mov_b32 s41, 7168
    v_mul_lo_u32 v12, v12, s41
    v_and_b32 v11, 15, v2
    v_lshrrev_b32 v14, 1, v11
    v_xor_b32 v14, v14, v13
    v_lshlrev_b32 v14, 5, v14
    v_and_b32 v11, 1, v11
    v_lshlrev_b32 v11, 4, v11
    v_add3_u32 v11, v11, v14, v12
    s_lshl_b32 s42, s30, 10
    s_mov_b32 s43, 0
    s_mov_b32 s44, s28
    s_mov_b32 s45, s29
    s_waitcnt lgkmcnt(0)
    s_mov_b32 s12, s4
    s_mov_b32 s13, s5
    s_mov_b32 s14, 4194304
    s_mov_b32 s15, 0x20000
    s_mov_b32 s16, s6
    s_mov_b32 s17, s7
    s_mov_b32 s18, 7340032
    s_mov_b32 s19, 0x20000
    s_add_u32 s46, s42, s43
    s_add_u32 m0, s46, 0
    s_mov_b32 s47, s44
    buffer_load_dwordx4 v10, s[12:15], s47 offen lds
    s_add_u32 m0, s46, 4096
    s_add_u32 s47, s44, 1048576
    buffer_load_dwordx4 v10, s[12:15], s47 offen lds
    s_add_u32 m0, s46, 8192
    s_add_u32 s47, s44, 2097152
    buffer_load_dwordx4 v10, s[12:15], s47 offen lds
    s_add_u32 m0, s46, 12288
    s_add_u32 s47, s44, 3145728
    buffer_load_dwordx4 v10, s[12:15], s47 offen lds
    s_add_u32 m0, s46, 16384
    s_add_u32 s47, s44, 32768
    buffer_load_dwordx4 v10, s[12:15], s47 offen lds
    s_add_u32 m0, s46, 20480
    s_add_u32 s47, s44, 1081344
    buffer_load_dwordx4 v10, s[12:15], s47 offen lds
    s_add_u32 m0, s46, 24576
    s_add_u32 s47, s44, 2129920
    buffer_load_dwordx4 v10, s[12:15], s47 offen lds
    s_add_u32 m0, s46, 28672
    s_add_u32 s47, s44, 3178496
    buffer_load_dwordx4 v10, s[12:15], s47 offen lds
    s_add_u32 m0, s46, 32768
    s_mov_b32 s47, s45
    buffer_load_dwordx4 v11, s[16:19], s47 offen lds
    s_add_u32 m0, s46, 36864
    s_add_u32 s47, s45, 114688
    buffer_load_dwordx4 v11, s[16:19], s47 offen lds
    s_add_u32 m0, s46, 40960
    s_add_u32 s47, s45, 229376
    buffer_load_dwordx4 v11, s[16:19], s47 offen lds
    s_add_u32 m0, s46, 45056
    s_add_u32 s47, s45, 344064
    buffer_load_dwordx4 v11, s[16:19], s47 offen lds
    s_add_u32 s44, s44, 128
    s_add_u32 s45, s45, 458752
    s_add_u32 s43, s43, 49152
    s_cmp_eq_u32 s43, 147456
    s_cselect_b32 s43, 0, s43
    s_load_dwordx2 s[4:5], s[0:1], 8
    s_load_dwordx2 s[6:7], s[0:1], 16
    s_mul_i32 s32, s20, 28
    s_add_u32 s32, s32, s21
    s_lshl_b32 s32, s32, 2
    s_add_u32 s32, s32, s30
    v_lshlrev_b32 v16, 4, v2
    s_lshl_b32 s35, s32, 11
    s_add_u32 s46, s42, s43
    s_add_u32 m0, s46, 0
    s_mov_b32 s47, s44
    buffer_load_dwordx4 v10, s[12:15], s47 offen lds
    s_add_u32 m0, s46, 4096
    s_add_u32 s47, s44, 1048576
    buffer_load_dwordx4 v10, s[12:15], s47 offen lds
    s_add_u32 m0, s46, 8192
    s_add_u32 s47, s44, 2097152
    buffer_load_dwordx4 v10, s[12:15], s47 offen lds
    s_add_u32 m0, s46, 12288
    s_add_u32 s47, s44, 3145728
    buffer_load_dwordx4 v10, s[12:15], s47 offen lds
    s_add_u32 m0, s46, 16384
    s_add_u32 s47, s44, 32768
    buffer_load_dwordx4 v10, s[12:15], s47 offen lds
    s_add_u32 m0, s46, 20480
    s_add_u32 s47, s44, 1081344
    buffer_load_dwordx4 v10, s[12:15], s47 offen lds
    s_add_u32 m0, s46, 24576
    s_add_u32 s47, s44, 2129920
    buffer_load_dwordx4 v10, s[12:15], s47 offen lds
    s_add_u32 m0, s46, 28672
    s_add_u32 s47, s44, 3178496
    buffer_load_dwordx4 v10, s[12:15], s47 offen lds
    s_add_u32 m0, s46, 32768
    s_mov_b32 s47, s45
    buffer_load_dwordx4 v11, s[16:19], s47 offen lds
    s_add_u32 m0, s46, 36864
    s_add_u32 s47, s45, 114688
    buffer_load_dwordx4 v11, s[16:19], s47 offen lds
    s_add_u32 m0, s46, 40960
    s_add_u32 s47, s45, 229376
    buffer_load_dwordx4 v11, s[16:19], s47 offen lds
    s_add_u32 m0, s46, 45056
    s_add_u32 s47, s45, 344064
    buffer_load_dwordx4 v11, s[16:19], s47 offen lds
    s_add_u32 s44, s44, 128
    s_add_u32 s45, s45, 458752
    s_add_u32 s43, s43, 49152
    s_cmp_eq_u32 s43, 147456
    s_cselect_b32 s43, 0, s43
    s_waitcnt lgkmcnt(0)
    s_add_u32 s96, s8, 58720256
    s_addc_u32 s97, s9, 0
    s_mov_b32 s98, 40960
    s_mov_b32 s99, 0x20000
    s_mov_b32 s52, s4
    s_mov_b32 s53, s5
    s_mov_b32 s54, 2101248
    s_mov_b32 s55, 0x20000
    s_mov_b32 s56, s6
    s_mov_b32 s57, s7
    s_mov_b32 s58, 2101248
    s_mov_b32 s59, 0x20000
    s_add_u32 s60, s8, 41943040
    s_addc_u32 s61, s9, 0
    s_mov_b32 s62, 4210688
    s_mov_b32 s63, 0x20000
    s_mul_i32 s28, s32, 3072
    s_add_u32 s40, s28, 917504
    buffer_load_dwordx4 v[192:195], v16, s[16:19], s40 offen
    s_add_u32 s40, s28, 918528
    buffer_load_dwordx4 v[196:199], v16, s[16:19], s40 offen
    s_add_u32 s40, s28, 919552
    buffer_load_dwordx4 v[200:203], v16, s[16:19], s40 offen
    s_lshl_b32 s36, s30, 12
    s_add_u32 s36, s36, 147456
    s_and_b32 s80, s32, 127
    s_lshr_b32 s81, s32, 7
    s_cmp_ge_u32 s81, 3
    s_cselect_b32 s82, 1, 0
    s_add_u32 s81, s81, 1
    s_add_u32 s81, s81, s82
    s_lshl_b32 s85, s80, 4
    s_add_u32 s85, s85, s81
    s_mul_i32 s83, s85, 1026
    s_lshl_b32 s84, s82, 1
    s_add_u32 s83, s83, s84
    s_and_b32 s84, s83, 2
    s_and_b32 s83, s83, 0xfffffffc
    s_cmp_lt_u32 s32, 768
    s_cselect_b32 s33, 1, 0
    s_mov_b32 s48, 0
RL_4:
    s_mov_b32 s40, 1011
    s_bitcmp1_b32 s40, s48
    s_cbranch_scc1 RLws_5
    s_waitcnt vmcnt(12)
RLwr_6:
    s_barrier
    s_add_u32 s46, s42, s43
    s_add_u32 m0, s46, 0
    s_mov_b32 s47, s44
    buffer_load_dwordx4 v10, s[12:15], s47 offen lds
    s_add_u32 m0, s46, 4096
    s_add_u32 s47, s44, 1048576
    buffer_load_dwordx4 v10, s[12:15], s47 offen lds
    s_add_u32 m0, s46, 8192
    s_add_u32 s47, s44, 2097152
    buffer_load_dwordx4 v10, s[12:15], s47 offen lds
    s_add_u32 m0, s46, 12288
    s_add_u32 s47, s44, 3145728
    buffer_load_dwordx4 v10, s[12:15], s47 offen lds
    s_add_u32 m0, s46, 16384
    s_add_u32 s47, s44, 32768
    buffer_load_dwordx4 v10, s[12:15], s47 offen lds
    s_add_u32 m0, s46, 20480
    s_add_u32 s47, s44, 1081344
    buffer_load_dwordx4 v10, s[12:15], s47 offen lds
    s_add_u32 m0, s46, 24576
    s_add_u32 s47, s44, 2129920
    buffer_load_dwordx4 v10, s[12:15], s47 offen lds
    s_add_u32 m0, s46, 28672
    s_add_u32 s47, s44, 3178496
    buffer_load_dwordx4 v10, s[12:15], s47 offen lds
    s_add_u32 m0, s46, 32768
    s_mov_b32 s47, s45
    buffer_load_dwordx4 v11, s[16:19], s47 offen lds
    s_add_u32 m0, s46, 36864
    s_add_u32 s47, s45, 114688
    buffer_load_dwordx4 v11, s[16:19], s47 offen lds
    s_add_u32 m0, s46, 40960
    s_add_u32 s47, s45, 229376
    buffer_load_dwordx4 v11, s[16:19], s47 offen lds
    s_add_u32 m0, s46, 45056
    s_add_u32 s47, s45, 344064
    buffer_load_dwordx4 v11, s[16:19], s47 offen lds
    s_add_u32 s44, s44, 128
    s_add_u32 s45, s45, 458752
    s_add_u32 s43, s43, 49152
    s_cmp_eq_u32 s43, 147456
    s_cselect_b32 s43, 0, s43
    s_mov_b32 s40, 2728
    s_bitcmp1_b32 s40, s48
    s_cbranch_scc1 RLhs_9
RLhr_10:
    s_add_u32 s48, s48, 1
    s_cmp_lt_u32 s48, 14
    s_cbranch_scc1 RL_4
    s_branch RLe_11
RLws_5:
    s_cmp_eq_u32 s48, 0
    s_cbranch_scc0 RLn_12
    s_waitcnt vmcnt(15)
    s_branch RLwr_6
RLn_12:
    s_cmp_eq_u32 s48, 1
    s_cbranch_scc0 RLn_13
    s_waitcnt vmcnt(15)
    s_branch RLwr_6
RLn_13:
    s_cmp_eq_u32 s48, 4
    s_cbranch_scc0 RLn_14
    s_waitcnt vmcnt(14)
    s_branch RLwr_6
RLn_14:
    s_cmp_eq_u32 s48, 5
    s_cbranch_scc0 RLn_15
    s_waitcnt vmcnt(14)
    s_branch RLwr_6
RLn_15:
    s_cmp_eq_u32 s48, 6
    s_cbranch_scc0 RLn_16
    s_cmp_eq_u32 s33, 1
    s_cbranch_scc0 RLu_17
    s_waitcnt vmcnt(20)
    s_branch RLu_18
RLu_17:
    s_waitcnt vmcnt(12)
RLu_18:
    s_branch RLwr_6
RLn_16:
    s_cmp_eq_u32 s48, 7
    s_cbranch_scc0 RLn_19
    s_cmp_eq_u32 s33, 1
    s_cbranch_scc0 RLu_20
    s_waitcnt vmcnt(20)
    s_branch RLu_21
RLu_20:
    s_waitcnt vmcnt(12)
RLu_21:
    s_branch RLwr_6
RLn_19:
    s_cmp_eq_u32 s48, 8
    s_cbranch_scc0 RLn_22
    s_waitcnt vmcnt(14)
    s_branch RLwr_6
RLn_22:
    s_waitcnt vmcnt(14)
    s_branch RLwr_6
RLhs_9:
    s_cmp_eq_u32 s48, 3
    s_cbranch_scc0 RLn_24
    s_mul_i32 s28, s32, 2048
    s_add_u32 s40, s28, 3670016
    buffer_load_dwordx4 v[192:195], v16, s[16:19], s40 offen
    s_add_u32 s40, s28, 3671040
    buffer_load_dwordx4 v[196:199], v16, s[16:19], s40 offen
    s_branch RLhr_10
RLn_24:
    s_cmp_eq_u32 s48, 5
    s_cbranch_scc0 RLn_25
    s_cmp_eq_u32 s33, 1
    s_cbranch_scc0 Only_26
    v_lshlrev_b32 v20, 4, v2
    s_add_u32 s40, s83, 0
    buffer_load_dwordx4 v[32:35], v20, s[52:55], s40 offen nt
    buffer_load_dwordx4 v[48:51], v20, s[56:59], s40 offen nt
    s_add_u32 s40, s83, 8208
    buffer_load_dwordx4 v[36:39], v20, s[52:55], s40 offen nt
    buffer_load_dwordx4 v[52:55], v20, s[56:59], s40 offen nt
    s_cmp_eq_u32 s84, 0
    s_cbranch_scc1 WN_27
    s_mov_b32 exec_lo, 0
    s_mov_b32 exec_hi, 0x80000000
    s_add_u32 s40, s83, 0
    buffer_load_dword v56, v20, s[52:55], s40 offen offset:16
    buffer_load_dword v58, v20, s[56:59], s40 offen offset:16
    s_add_u32 s40, s83, 8208
    buffer_load_dword v57, v20, s[52:55], s40 offen offset:16
    buffer_load_dword v59, v20, s[56:59], s40 offen offset:16
    s_mov_b64 exec, -1
WN_27:
    v_and_b32 v21, 1, v2
    v_lshlrev_b32 v21, 3, v21
    v_add_u32 v21, s85, v21
    v_sub_u32 v22, 2048, v21
    v_and_b32 v22, 2047, v22
    s_mov_b32 s40, 1026
    v_mul_lo_u32 v21, v21, s40
    v_mul_lo_u32 v22, v22, s40
    s_lshl_b32 s40, s82, 10
    s_mov_b64 exec, 3
    buffer_load_ushort v64, v21, s[52:55], s40 offen
    buffer_load_ushort v65, v21, s[56:59], s40 offen
    buffer_load_ushort v68, v22, s[52:55], s40 offen
    buffer_load_ushort v69, v22, s[56:59], s40 offen
    s_mov_b64 exec, -1
Only_26:
    s_branch RLhr_10
RLn_25:
    s_cmp_eq_u32 s48, 7
    s_cbranch_scc0 RLn_28
    s_mul_i32 s28, s32, 2048
    s_add_u32 s40, s28, 5505024
    buffer_load_dwordx4 v[192:195], v16, s[16:19], s40 offen
    s_add_u32 s40, s28, 5506048
    buffer_load_dwordx4 v[196:199], v16, s[16:19], s40 offen
    s_branch RLhr_10
RLn_28:
    s_cmp_eq_u32 s48, 9
    s_cbranch_scc0 RLn_29
    s_cmp_eq_u32 s30, 0
    s_cbranch_scc0 Only_30
    s_load_dwordx2 s[4:5], s[0:1], 64
    s_waitcnt lgkmcnt(0)
    s_mov_b32 s6, 256
    s_mov_b32 s7, 0x20000
    v_mov_b32 v4, 0
    buffer_load_dword v6, v4, s[4:7], 0 offen sc1
Only_30:
    s_branch RLhr_10
RLn_29:
    s_cmp_eq_u32 s30, 0
    s_cbranch_scc0 Only_32
    v_readfirstlane_b32 s40, v6
    s_cmp_ge_u32 s40, 1
    s_cbranch_scc1 iw_33
    s_load_dwordx2 s[4:5], s[0:1], 64
    s_waitcnt lgkmcnt(0)
    s_mov_b32 s6, 256
    s_mov_b32 s7, 0x20000
    v_mov_b32 v4, 0
    s_mov_b32 s41, 0
PI_34:
    buffer_load_dword v5, v4, s[4:7], 0 offen sc1
    s_waitcnt vmcnt(0)
    v_readfirstlane_b32 s40, v5
    s_add_u32 s41, s41, 1
    s_cmp_ge_u32 s40, 1
    s_cbranch_scc1 PID_35
    s_cmp_ge_u32 s41, 100000
    s_cbranch_scc1 PID_35
    s_sleep 2
    s_branch PI_34
PID_35:
iw_33:
Only_32:
    s_branch RLhr_10
RLe_11:
    s_cmp_eq_u32 s33, 1
    s_cbranch_scc0 Only_36
    s_cmp_eq_u32 s84, 0
    s_cbranch_scc1 WN_37
    v_mov_b32_dpp v56, v32 wave_shl:1 row_mask:0xf bank_mask:0xf
    v_alignbit_b32 v32, v33, v32, 16
    v_alignbit_b32 v33, v34, v33, 16
    v_alignbit_b32 v34, v35, v34, 16
    v_alignbit_b32 v35, v56, v35, 16
    v_mov_b32_dpp v58, v48 wave_shl:1 row_mask:0xf bank_mask:0xf
    v_alignbit_b32 v48, v49, v48, 16
    v_alignbit_b32 v49, v50, v49, 16
    v_alignbit_b32 v50, v51, v50, 16
    v_alignbit_b32 v51, v58, v51, 16
    v_mov_b32_dpp v57, v36 wave_shl:1 row_mask:0xf bank_mask:0xf
    v_alignbit_b32 v36, v37, v36, 16
    v_alignbit_b32 v37, v38, v37, 16
    v_alignbit_b32 v38, v39, v38, 16
    v_alignbit_b32 v39, v57, v39, 16
    v_mov_b32_dpp v59, v52 wave_shl:1 row_mask:0xf bank_mask:0xf
    v_alignbit_b32 v52, v53, v52, 16
    v_alignbit_b32 v53, v54, v53, 16
    v_alignbit_b32 v54, v55, v54, 16
    v_alignbit_b32 v55, v59, v55, 16
WN_37:
    s_mov_b32 s86, 0x05040100
    s_mov_b32 s87, 0x07060302
    v_lshrrev_b32 v20, 1, v2
    v_and_b32 v21, 1, v2
    s_cmp_eq_u32 s82, 1
    s_cbranch_scc0 WN_38
    v_sub_u32 v20, 31, v20
    v_xor_b32 v21, 1, v21
WN_38:
    v_lshlrev_b32 v21, 1, v21
    v_and_b32 v22, 7, v20
    v_lshlrev_b32 v23, 7, v20
    v_add_u32 v23, s36, v23
    s_cmp_eq_u32 s82, 1
    s_cbranch_scc1 WN_39
    v_perm_b32 v150, v48, v32, s86
    v_perm_b32 v151, v48, v32, s87
    v_perm_b32 v152, v49, v33, s86
    v_perm_b32 v153, v49, v33, s87
    v_perm_b32 v154, v50, v34, s86
    v_perm_b32 v155, v50, v34, s87
    v_perm_b32 v156, v51, v35, s86
    v_perm_b32 v157, v51, v35, s87
    v_add_u32 v24, 0, v21
    v_xor_b32 v24, v24, v22
    v_lshl_add_u32 v24, v24, 4, v23
    ds_write_b128 v24, v[150:153]
    v_add_u32 v27, 1, v21
    v_xor_b32 v27, v27, v22
    v_lshl_add_u32 v27, v27, 4, v23
    ds_write_b128 v27, v[154:157]
    s_branch WN_40
WN_39:
    v_perm_b32 v150, v51, v35, s87
    v_xor_b32 v150, 0x80000000, v150
    v_perm_b32 v151, v51, v35, s86
    v_xor_b32 v151, 0x80000000, v151
    v_perm_b32 v152, v50, v34, s87
    v_xor_b32 v152, 0x80000000, v152
    v_perm_b32 v153, v50, v34, s86
    v_xor_b32 v153, 0x80000000, v153
    v_perm_b32 v154, v49, v33, s87
    v_xor_b32 v154, 0x80000000, v154
    v_perm_b32 v155, v49, v33, s86
    v_xor_b32 v155, 0x80000000, v155
    v_perm_b32 v156, v48, v32, s87
    v_xor_b32 v156, 0x80000000, v156
    v_perm_b32 v157, v48, v32, s86
    v_xor_b32 v157, 0x80000000, v157
    v_add_u32 v24, 4, v21
    v_xor_b32 v24, v24, v22
    v_lshl_add_u32 v24, v24, 4, v23
    ds_write_b128 v24, v[150:153]
    v_add_u32 v27, 5, v21
    v_xor_b32 v27, v27, v22
    v_lshl_add_u32 v27, v27, 4, v23
    ds_write_b128 v27, v[154:157]
WN_40:
Only_36:
    s_waitcnt vmcnt(12)
    s_barrier
    s_cmp_eq_u32 s33, 1
    s_cbranch_scc0 Only_41
    s_cmp_eq_u32 s82, 1
    s_cbranch_scc1 WN_42
    v_perm_b32 v150, v52, v36, s86
    v_perm_b32 v151, v52, v36, s87
    v_perm_b32 v152, v53, v37, s86
    v_perm_b32 v153, v53, v37, s87
    v_perm_b32 v154, v54, v38, s86
    v_perm_b32 v155, v54, v38, s87
    v_perm_b32 v156, v55, v39, s86
    v_perm_b32 v157, v55, v39, s87
    v_add_u32 v24, 4, v21
    v_xor_b32 v24, v24, v22
    v_lshl_add_u32 v24, v24, 4, v23
    ds_write_b128 v24, v[150:153]
    v_add_u32 v27, 5, v21
    v_xor_b32 v27, v27, v22
    v_lshl_add_u32 v27, v27, 4, v23
    ds_write_b128 v27, v[154:157]
    s_branch WN_43
WN_42:
    v_perm_b32 v150, v55, v39, s87
    v_xor_b32 v150, 0x80000000, v150
    v_perm_b32 v151, v55, v39, s86
    v_xor_b32 v151, 0x80000000, v151
    v_perm_b32 v152, v54, v38, s87
    v_xor_b32 v152, 0x80000000, v152
    v_perm_b32 v153, v54, v38, s86
    v_xor_b32 v153, 0x80000000, v153
    v_perm_b32 v154, v53, v37, s87
    v_xor_b32 v154, 0x80000000, v154
    v_perm_b32 v155, v53, v37, s86
    v_xor_b32 v155, 0x80000000, v155
    v_perm_b32 v156, v52, v36, s87
    v_xor_b32 v156, 0x80000000, v156
    v_perm_b32 v157, v52, v36, s86
    v_xor_b32 v157, 0x80000000, v157
    v_add_u32 v24, 0, v21
    v_xor_b32 v24, v24, v22
    v_lshl_add_u32 v24, v24, 4, v23
    ds_write_b128 v24, v[150:153]
    v_add_u32 v27, 1, v21
    v_xor_b32 v27, v27, v22
    v_lshl_add_u32 v27, v27, 4, v23
    ds_write_b128 v27, v[154:157]
WN_43:
    v_lshlrev_b32 v64, 16, v64
    v_lshlrev_b32 v65, 16, v65
    v_lshlrev_b32 v68, 16, v68
    v_lshlrev_b32 v69, 16, v69
    s_cmp_eq_u32 s82, 1
    s_cselect_b32 s41, 3204448256, 0
    s_mov_b32 s40, 1056964608
    s_cselect_b32 s41, s41, s40
    v_add_f32 v24, v64, v68
    v_sub_f32 v25, v65, v69
    v_mul_f32 v24, 0.5, v24
    v_mul_f32 v25, s41, v25
    v_cvt_pk_bf16_f32 v72, v24, v25
    v_mov_b32 v73, v72
    v_and_b32 v24, 1, v2
    s_mov_b64 exec, 3
    s_cmp_eq_u32 s82, 1
    s_cbranch_scc1 WN_44
    v_lshlrev_b32 v24, 6, v24
    v_add_u32 v24, s36, v24
    ds_write_b32 v24, v72
    s_branch WN_45
WN_44:
    v_xor_b32 v24, 1, v24
    v_lshlrev_b32 v24, 6, v24
    v_add_u32 v24, s36, v24
    ds_write_b32 v24, v73
WN_45:
    s_mov_b64 exec, -1
Only_41:
    s_waitcnt vmcnt(0)
    s_barrier
    s_load_dwordx2 s[6:7], s[0:1], 40
    s_waitcnt lgkmcnt(0)
    s_mov_b32 s16, s6
    s_mov_b32 s17, s7
    s_mov_b32 s18, 7340032
    s_mov_b32 s19, 0x20000
    s_lshl_b32 s50, s2, 2
    s_add_u32 s50, s50, s30
    s_mul_i32 s50, s50, 7168
    s_add_u32 s40, s50, 0
    buffer_load_dwordx4 v[200:203], v16, s[16:19], s40 offen
    s_add_u32 s40, s50, 1024
    buffer_load_dwordx4 v[204:207], v16, s[16:19], s40 offen
    s_add_u32 s40, s50, 2048
    buffer_load_dwordx4 v[208:211], v16, s[16:19], s40 offen
    s_add_u32 s40, s50, 3072
    buffer_load_dwordx4 v[212:215], v16, s[16:19], s40 offen
    s_add_u32 s40, s50, 4096
    buffer_load_dwordx4 v[216:219], v16, s[16:19], s40 offen
    s_add_u32 s40, s50, 5120
    buffer_load_dwordx4 v[220:223], v16, s[16:19], s40 offen
    s_add_u32 s40, s50, 6144
    buffer_load_dwordx4 v[224:227], v16, s[16:19], s40 offen
    s_cmp_eq_u32 s33, 1
    s_cbranch_scc0 Only_46
    v_lshrrev_b32 v20, 3, v2
    v_and_b32 v21, 7, v2
    v_xor_b32 v22, v20, v21
    v_lshlrev_b32 v22, 4, v22
    v_lshl_add_u32 v25, v20, 7, v22
    v_add_u32 v25, s36, v25
    v_lshlrev_b32 v20, 14, v20
    v_lshl_add_u32 v26, v21, 4, v20
    s_lshl_b32 s88, s80, 7
    s_cmp_eq_u32 s82, 1
    s_cbranch_scc1 WN_47
    s_sub_u32 s89, s81, 1
    s_lshl_b32 s89, s89, 20
    s_add_u32 s89, s89, s88
    s_branch WN_48
WN_47:
    s_sub_u32 s89, 7, s81
    s_lshl_b32 s89, s89, 20
    s_add_u32 s89, s89, 540544
    s_sub_u32 s89, s89, s88
WN_48:
    s_waitcnt lgkmcnt(0)
    ds_read_b128 v[150:153], v25 offset:0
    ds_read_b128 v[154:157], v25 offset:1024
    ds_read_b128 v[158:161], v25 offset:2048
    ds_read_b128 v[162:165], v25 offset:3072
    s_waitcnt lgkmcnt(3)
    s_add_u32 s40, s89, 0
    buffer_store_dwordx4 v[150:153], v26, s[60:63], s40 offen sc1
    s_waitcnt lgkmcnt(2)
    s_add_u32 s40, s89, 131072
    buffer_store_dwordx4 v[154:157], v26, s[60:63], s40 offen sc1
    s_waitcnt lgkmcnt(1)
    s_add_u32 s40, s89, 262144
    buffer_store_dwordx4 v[158:161], v26, s[60:63], s40 offen sc1
    s_waitcnt lgkmcnt(0)
    s_add_u32 s40, s89, 393216
    buffer_store_dwordx4 v[162:165], v26, s[60:63], s40 offen sc1
    s_waitcnt vmcnt(0)
    s_lshl_b32 s50, s20, 2
    s_and_b32 s51, s21, 3
    s_add_u32 s50, s50, s51
    s_lshl_b32 s50, s50, 7
    v_mbcnt_lo_u32_b32 v4, -1, 0
    v_mbcnt_hi_u32_b32 v4, -1, v4
    v_lshlrev_b32 v4, 12, v4
    s_add_u32 s40, s50, 8192
    v_add_u32 v4, s40, v4
    v_mov_b32 v5, 1
    s_mov_b64 exec, 255
    buffer_atomic_add v5, v4, s[96:99], 0 offen
    s_mov_b64 exec, -1
Only_46:
    s_lshl_b32 s33, s22, 1
    s_cmp_ge_u32 s23, 14
    s_addc_u32 s33, s33, 0
    s_lshl_b32 s33, s33, 7
    s_mov_b32 s34, 1
    s_branch F_common1
F_g1cons:
    s_waitcnt lgkmcnt(0)
    s_add_u32 s96, s8, 58720256
    s_addc_u32 s97, s9, 0
    s_mov_b32 s98, 40960
    s_mov_b32 s99, 0x20000
    s_mov_b32 s24, s8
    s_mov_b32 s25, s9
    s_mov_b32 s26, 14680064
    s_mov_b32 s27, 0x20000
    s_cmp_eq_u32 s2, 0
    s_cbranch_scc0 Only_49
    s_cmp_eq_u32 s31, 0
    s_cbranch_scc0 Only_50
    s_load_dwordx2 s[44:45], s[0:1], 64
    v_lshlrev_b32 v4, 7, v2
    v_mov_b32 v5, 0
    buffer_store_dword v5, v4, s[96:99], 0 offen sc1
    v_add_u32 v4, 8192, v4
    buffer_store_dword v5, v4, s[96:99], 0 offen sc1
    v_add_u32 v4, 8192, v4
    buffer_store_dword v5, v4, s[96:99], 0 offen sc1
    v_add_u32 v4, 8192, v4
    buffer_store_dword v5, v4, s[96:99], 0 offen sc1
    v_add_u32 v4, 8192, v4
    buffer_store_dword v5, v4, s[96:99], 0 offen sc1
    s_waitcnt vmcnt(0) lgkmcnt(0)
    s_mov_b32 s46, 256
    s_mov_b32 s47, 0x20000
    v_mov_b32 v4, 0
    v_mov_b32 v5, 1
    s_mov_b64 exec, 1
    buffer_store_dword v5, v4, s[44:47], 0 offen sc1
    s_mov_b64 exec, -1
Only_50:
Only_49:
    s_and_b32 s40, s31, 1
    s_lshr_b32 s41, s31, 1
    v_and_b32 v4, 15, v2
    v_lshrrev_b32 v5, 4, v2
    s_mul_i32 s46, s40, 16384
    v_lshlrev_b32 v6, 7, v4
    v_lshrrev_b32 v7, 1, v4
    v_xor_b32 v7, v7, v5
    v_lshlrev_b32 v7, 4, v7
    v_add3_u32 v12, v6, v7, s46
    v_xor_b32 v13, 64, v12
    v_lshrrev_b32 v6, 2, v4
    v_and_b32 v7, 3, v4
    v_lshl_add_u32 v8, v5, 3, v6
    v_and_b32 v9, 1, v5
    v_lshl_or_b32 v9, v9, 2, v6
    v_lshlrev_b32 v8, 8, v8
    v_lshl_add_u32 v8, v7, 3, v8
    s_lshl_b32 s46, s41, 2
    s_add_u32 s47, s46, 0
    v_xor_b32 v10, s47, v9
    v_lshl_add_u32 v10, v10, 5, v8
    v_add_u32 v14, 32768, v10
    s_add_u32 s47, s46, 1
    v_xor_b32 v10, s47, v9
    v_lshl_add_u32 v10, v10, 5, v8
    v_add_u32 v15, 32768, v10
    s_add_u32 s47, s46, 2
    v_xor_b32 v10, s47, v9
    v_lshl_add_u32 v10, v10, 5, v8
    v_add_u32 v16, 32768, v10
    s_add_u32 s47, s46, 3
    v_xor_b32 v10, s47, v9
    v_lshl_add_u32 v10, v10, 5, v8
    v_add_u32 v17, 32768, v10
    v_mov_b32 v128, 0
    v_mov_b32 v129, 0
    v_mov_b32 v130, 0
    v_mov_b32 v131, 0
    v_mov_b32 v132, 0
    v_mov_b32 v133, 0
    v_mov_b32 v134, 0
    v_mov_b32 v135, 0
    v_mov_b32 v136, 0
    v_mov_b32 v137, 0
    v_mov_b32 v138, 0
    v_mov_b32 v139, 0
    v_mov_b32 v140, 0
    v_mov_b32 v141, 0
    v_mov_b32 v142, 0
    v_mov_b32 v143, 0
    v_mov_b32 v144, 0
    v_mov_b32 v145, 0
    v_mov_b32 v146, 0
    v_mov_b32 v147, 0
    v_mov_b32 v148, 0
    v_mov_b32 v149, 0
    v_mov_b32 v150, 0
    v_mov_b32 v151, 0
    v_mov_b32 v152, 0
    v_mov_b32 v153, 0
    v_mov_b32 v154, 0
    v_mov_b32 v155, 0
    v_mov_b32 v156, 0
    v_mov_b32 v157, 0
    v_mov_b32 v158, 0
    v_mov_b32 v159, 0
    v_mov_b32 v160, 0
    v_mov_b32 v161, 0
    v_mov_b32 v162, 0
    v_mov_b32 v163, 0
    v_mov_b32 v164, 0
    v_mov_b32 v165, 0
    v_mov_b32 v166, 0
    v_mov_b32 v167, 0
    v_mov_b32 v168, 0
    v_mov_b32 v169, 0
    v_mov_b32 v170, 0
    v_mov_b32 v171, 0
    v_mov_b32 v172, 0
    v_mov_b32 v173, 0
    v_mov_b32 v174, 0
    v_mov_b32 v175, 0
    v_mov_b32 v176, 0
    v_mov_b32 v177, 0
    v_mov_b32 v178, 0
    v_mov_b32 v179, 0
    v_mov_b32 v180, 0
    v_mov_b32 v181, 0
    v_mov_b32 v182, 0
    v_mov_b32 v183, 0
    v_mov_b32 v184, 0
    v_mov_b32 v185, 0
    v_mov_b32 v186, 0
    v_mov_b32 v187, 0
    v_mov_b32 v188, 0
    v_mov_b32 v189, 0
    v_mov_b32 v190, 0
    v_mov_b32 v191, 0
    v_mov_b32 v192, 0
    v_mov_b32 v193, 0
    v_mov_b32 v194, 0
    v_mov_b32 v195, 0
    v_mov_b32 v196, 0
    v_mov_b32 v197, 0
    v_mov_b32 v198, 0
    v_mov_b32 v199, 0
    v_mov_b32 v200, 0
    v_mov_b32 v201, 0
    v_mov_b32 v202, 0
    v_mov_b32 v203, 0
    v_mov_b32 v204, 0
    v_mov_b32 v205, 0
    v_mov_b32 v206, 0
    v_mov_b32 v207, 0
    v_mov_b32 v208, 0
    v_mov_b32 v209, 0
    v_mov_b32 v210, 0
    v_mov_b32 v211, 0
    v_mov_b32 v212, 0
    v_mov_b32 v213, 0
    v_mov_b32 v214, 0
    v_mov_b32 v215, 0
    v_mov_b32 v216, 0
    v_mov_b32 v217, 0
    v_mov_b32 v218, 0
    v_mov_b32 v219, 0
    v_mov_b32 v220, 0
    v_mov_b32 v221, 0
    v_mov_b32 v222, 0
    v_mov_b32 v223, 0
    v_mov_b32 v224, 0
    v_mov_b32 v225, 0
    v_mov_b32 v226, 0
    v_mov_b32 v227, 0
    v_mov_b32 v228, 0
    v_mov_b32 v229, 0
    v_mov_b32 v230, 0
    v_mov_b32 v231, 0
    v_mov_b32 v232, 0
    v_mov_b32 v233, 0
    v_mov_b32 v234, 0
    v_mov_b32 v235, 0
    v_mov_b32 v236, 0
    v_mov_b32 v237, 0
    v_mov_b32 v238, 0
    v_mov_b32 v239, 0
    v_mov_b32 v240, 0
    v_mov_b32 v241, 0
    v_mov_b32 v242, 0
    v_mov_b32 v243, 0
    v_mov_b32 v244, 0
    v_mov_b32 v245, 0
    v_mov_b32 v246, 0
    v_mov_b32 v247, 0
    v_mov_b32 v248, 0
    v_mov_b32 v249, 0
    v_mov_b32 v250, 0
    v_mov_b32 v251, 0
    v_mov_b32 v252, 0
    v_mov_b32 v253, 0
    v_mov_b32 v254, 0
    v_mov_b32 v255, 0
    s_mov_b32 s48, 0
    s_mov_b32 s49, 0
    s_mov_b32 s50, 49152
    s_mov_b32 s51, 4294868992
    s_barrier
    ds_read_b64_tr_b16 v[52:53], v14 offset:0
    ds_read_b64_tr_b16 v[54:55], v14 offset:1024
    ds_read_b128 v[20:23], v12 offset:0
    ds_read_b128 v[24:27], v12 offset:2048
    ds_read_b128 v[28:31], v12 offset:4096
    ds_read_b64_tr_b16 v[56:57], v15 offset:0
    ds_read_b128 v[32:35], v12 offset:6144
    ds_read_b64_tr_b16 v[58:59], v15 offset:1024
    ds_read_b128 v[36:39], v12 offset:8192
    ds_read_b64_tr_b16 v[60:61], v16 offset:0
    ds_read_b128 v[40:43], v12 offset:10240
    ds_read_b64_tr_b16 v[62:63], v16 offset:1024
    ds_read_b128 v[44:47], v12 offset:12288
    ds_read_b64_tr_b16 v[64:65], v17 offset:0
    ds_read_b128 v[48:51], v12 offset:14336
    ds_read_b64_tr_b16 v[66:67], v17 offset:1024
Lc_51:
    s_add_u32 s49, s49, 1
    s_cmp_eq_u32 s49, 3
    s_cselect_b32 s47, s51, s50
    s_cselect_b32 s49, 0, s49
    s_waitcnt lgkmcnt(0)
    v_mfma_f32_16x16x32_bf16 v[128:131], v[52:55], v[20:23], v[128:131]
    ds_read_b64_tr_b16 v[100:101], v14 offset:8192
    v_mfma_f32_16x16x32_bf16 v[144:147], v[52:55], v[24:27], v[144:147]
    ds_read_b64_tr_b16 v[102:103], v14 offset:9216
    v_mfma_f32_16x16x32_bf16 v[160:163], v[52:55], v[28:31], v[160:163]
    ds_read_b128 v[68:71], v13 offset:0
    v_mfma_f32_16x16x32_bf16 v[176:179], v[52:55], v[32:35], v[176:179]
    v_mfma_f32_16x16x32_bf16 v[192:195], v[52:55], v[36:39], v[192:195]
    ds_read_b128 v[72:75], v13 offset:2048
    v_mfma_f32_16x16x32_bf16 v[208:211], v[52:55], v[40:43], v[208:211]
    ds_read_b128 v[76:79], v13 offset:4096
    v_mfma_f32_16x16x32_bf16 v[224:227], v[52:55], v[44:47], v[224:227]
    v_mfma_f32_16x16x32_bf16 v[240:243], v[52:55], v[48:51], v[240:243]
    ds_read_b64_tr_b16 v[104:105], v15 offset:8192
    v_mfma_f32_16x16x32_bf16 v[132:135], v[56:59], v[20:23], v[132:135]
    ds_read_b128 v[80:83], v13 offset:6144
    v_mfma_f32_16x16x32_bf16 v[148:151], v[56:59], v[24:27], v[148:151]
    ds_read_b64_tr_b16 v[106:107], v15 offset:9216
    v_mfma_f32_16x16x32_bf16 v[164:167], v[56:59], v[28:31], v[164:167]
    v_mfma_f32_16x16x32_bf16 v[180:183], v[56:59], v[32:35], v[180:183]
    ds_read_b128 v[84:87], v13 offset:8192
    v_mfma_f32_16x16x32_bf16 v[196:199], v[56:59], v[36:39], v[196:199]
    ds_read_b64_tr_b16 v[108:109], v16 offset:8192
    v_mfma_f32_16x16x32_bf16 v[212:215], v[56:59], v[40:43], v[212:215]
    v_mfma_f32_16x16x32_bf16 v[228:231], v[56:59], v[44:47], v[228:231]
    ds_read_b128 v[88:91], v13 offset:10240
    v_mfma_f32_16x16x32_bf16 v[244:247], v[56:59], v[48:51], v[244:247]
    ds_read_b64_tr_b16 v[110:111], v16 offset:9216
    v_mfma_f32_16x16x32_bf16 v[136:139], v[60:63], v[20:23], v[136:139]
    ds_read_b128 v[92:95], v13 offset:12288
    v_mfma_f32_16x16x32_bf16 v[152:155], v[60:63], v[24:27], v[152:155]
    v_mfma_f32_16x16x32_bf16 v[168:171], v[60:63], v[28:31], v[168:171]
    ds_read_b64_tr_b16 v[112:113], v17 offset:8192
    v_mfma_f32_16x16x32_bf16 v[184:187], v[60:63], v[32:35], v[184:187]
    ds_read_b128 v[96:99], v13 offset:14336
    v_mfma_f32_16x16x32_bf16 v[200:203], v[60:63], v[36:39], v[200:203]
    v_mfma_f32_16x16x32_bf16 v[216:219], v[60:63], v[40:43], v[216:219]
    ds_read_b64_tr_b16 v[114:115], v17 offset:9216
    v_mfma_f32_16x16x32_bf16 v[232:235], v[60:63], v[44:47], v[232:235]
    v_add_u32 v12, s47, v12
    v_mfma_f32_16x16x32_bf16 v[248:251], v[60:63], v[48:51], v[248:251]
    v_add_u32 v13, s47, v13
    v_mfma_f32_16x16x32_bf16 v[140:143], v[64:67], v[20:23], v[140:143]
    v_mfma_f32_16x16x32_bf16 v[156:159], v[64:67], v[24:27], v[156:159]
    v_add_u32 v14, s47, v14
    v_mfma_f32_16x16x32_bf16 v[172:175], v[64:67], v[28:31], v[172:175]
    v_add_u32 v15, s47, v15
    v_mfma_f32_16x16x32_bf16 v[188:191], v[64:67], v[32:35], v[188:191]
    v_mfma_f32_16x16x32_bf16 v[204:207], v[64:67], v[36:39], v[204:207]
    v_add_u32 v16, s47, v16
    v_mfma_f32_16x16x32_bf16 v[220:223], v[64:67], v[40:43], v[220:223]
    v_add_u32 v17, s47, v17
    v_mfma_f32_16x16x32_bf16 v[236:239], v[64:67], v[44:47], v[236:239]
    v_mfma_f32_16x16x32_bf16 v[252:255], v[64:67], v[48:51], v[252:255]
    s_waitcnt lgkmcnt(0)
    s_barrier
    v_mfma_f32_16x16x32_bf16 v[128:131], v[100:103], v[68:71], v[128:131]
    ds_read_b64_tr_b16 v[52:53], v14 offset:0
    v_mfma_f32_16x16x32_bf16 v[144:147], v[100:103], v[72:75], v[144:147]
    ds_read_b64_tr_b16 v[54:55], v14 offset:1024
    v_mfma_f32_16x16x32_bf16 v[160:163], v[100:103], v[76:79], v[160:163]
    v_mfma_f32_16x16x32_bf16 v[176:179], v[100:103], v[80:83], v[176:179]
    ds_read_b128 v[20:23], v12 offset:0
    v_mfma_f32_16x16x32_bf16 v[192:195], v[100:103], v[84:87], v[192:195]
    v_mfma_f32_16x16x32_bf16 v[208:211], v[100:103], v[88:91], v[208:211]
    ds_read_b128 v[24:27], v12 offset:2048
    v_mfma_f32_16x16x32_bf16 v[224:227], v[100:103], v[92:95], v[224:227]
    v_mfma_f32_16x16x32_bf16 v[240:243], v[100:103], v[96:99], v[240:243]
    ds_read_b128 v[28:31], v12 offset:4096
    v_mfma_f32_16x16x32_bf16 v[132:135], v[104:107], v[68:71], v[132:135]
    v_mfma_f32_16x16x32_bf16 v[148:151], v[104:107], v[72:75], v[148:151]
    ds_read_b64_tr_b16 v[56:57], v15 offset:0
    v_mfma_f32_16x16x32_bf16 v[164:167], v[104:107], v[76:79], v[164:167]
    v_mfma_f32_16x16x32_bf16 v[180:183], v[104:107], v[80:83], v[180:183]
    ds_read_b128 v[32:35], v12 offset:6144
    v_mfma_f32_16x16x32_bf16 v[196:199], v[104:107], v[84:87], v[196:199]
    v_mfma_f32_16x16x32_bf16 v[212:215], v[104:107], v[88:91], v[212:215]
    ds_read_b64_tr_b16 v[58:59], v15 offset:1024
    v_mfma_f32_16x16x32_bf16 v[228:231], v[104:107], v[92:95], v[228:231]
    v_mfma_f32_16x16x32_bf16 v[244:247], v[104:107], v[96:99], v[244:247]
    ds_read_b128 v[36:39], v12 offset:8192
    v_mfma_f32_16x16x32_bf16 v[136:139], v[108:111], v[68:71], v[136:139]
    v_mfma_f32_16x16x32_bf16 v[152:155], v[108:111], v[72:75], v[152:155]
    ds_read_b64_tr_b16 v[60:61], v16 offset:0
    v_mfma_f32_16x16x32_bf16 v[168:171], v[108:111], v[76:79], v[168:171]
    v_mfma_f32_16x16x32_bf16 v[184:187], v[108:111], v[80:83], v[184:187]
    ds_read_b128 v[40:43], v12 offset:10240
    v_mfma_f32_16x16x32_bf16 v[200:203], v[108:111], v[84:87], v[200:203]
    v_mfma_f32_16x16x32_bf16 v[216:219], v[108:111], v[88:91], v[216:219]
    ds_read_b64_tr_b16 v[62:63], v16 offset:1024
    v_mfma_f32_16x16x32_bf16 v[232:235], v[108:111], v[92:95], v[232:235]
    v_mfma_f32_16x16x32_bf16 v[248:251], v[108:111], v[96:99], v[248:251]
    ds_read_b128 v[44:47], v12 offset:12288
    v_mfma_f32_16x16x32_bf16 v[140:143], v[112:115], v[68:71], v[140:143]
    v_mfma_f32_16x16x32_bf16 v[156:159], v[112:115], v[72:75], v[156:159]
    ds_read_b64_tr_b16 v[64:65], v17 offset:0
    v_mfma_f32_16x16x32_bf16 v[172:175], v[112:115], v[76:79], v[172:175]
    v_mfma_f32_16x16x32_bf16 v[188:191], v[112:115], v[80:83], v[188:191]
    ds_read_b128 v[48:51], v12 offset:14336
    v_mfma_f32_16x16x32_bf16 v[204:207], v[112:115], v[84:87], v[204:207]
    v_mfma_f32_16x16x32_bf16 v[220:223], v[112:115], v[88:91], v[220:223]
    ds_read_b64_tr_b16 v[66:67], v17 offset:1024
    v_mfma_f32_16x16x32_bf16 v[236:239], v[112:115], v[92:95], v[236:239]
    v_mfma_f32_16x16x32_bf16 v[252:255], v[112:115], v[96:99], v[252:255]
    s_add_u32 s48, s48, 1
    s_cmp_lt_u32 s48, 15
    s_cbranch_scc1 Lc_51
    s_waitcnt lgkmcnt(0)
    v_mfma_f32_16x16x32_bf16 v[128:131], v[52:55], v[20:23], v[128:131]
    ds_read_b64_tr_b16 v[100:101], v14 offset:8192
    v_mfma_f32_16x16x32_bf16 v[144:147], v[52:55], v[24:27], v[144:147]
    ds_read_b64_tr_b16 v[102:103], v14 offset:9216
    v_mfma_f32_16x16x32_bf16 v[160:163], v[52:55], v[28:31], v[160:163]
    v_mfma_f32_16x16x32_bf16 v[176:179], v[52:55], v[32:35], v[176:179]
    ds_read_b128 v[68:71], v13 offset:0
    v_mfma_f32_16x16x32_bf16 v[192:195], v[52:55], v[36:39], v[192:195]
    v_mfma_f32_16x16x32_bf16 v[208:211], v[52:55], v[40:43], v[208:211]
    ds_read_b128 v[72:75], v13 offset:2048
    v_mfma_f32_16x16x32_bf16 v[224:227], v[52:55], v[44:47], v[224:227]
    v_mfma_f32_16x16x32_bf16 v[240:243], v[52:55], v[48:51], v[240:243]
    ds_read_b128 v[76:79], v13 offset:4096
    v_mfma_f32_16x16x32_bf16 v[132:135], v[56:59], v[20:23], v[132:135]
    v_mfma_f32_16x16x32_bf16 v[148:151], v[56:59], v[24:27], v[148:151]
    ds_read_b64_tr_b16 v[104:105], v15 offset:8192
    v_mfma_f32_16x16x32_bf16 v[164:167], v[56:59], v[28:31], v[164:167]
    v_mfma_f32_16x16x32_bf16 v[180:183], v[56:59], v[32:35], v[180:183]
    ds_read_b128 v[80:83], v13 offset:6144
    v_mfma_f32_16x16x32_bf16 v[196:199], v[56:59], v[36:39], v[196:199]
    v_mfma_f32_16x16x32_bf16 v[212:215], v[56:59], v[40:43], v[212:215]
    ds_read_b64_tr_b16 v[106:107], v15 offset:9216
    v_mfma_f32_16x16x32_bf16 v[228:231], v[56:59], v[44:47], v[228:231]
    v_mfma_f32_16x16x32_bf16 v[244:247], v[56:59], v[48:51], v[244:247]
    ds_read_b128 v[84:87], v13 offset:8192
    v_mfma_f32_16x16x32_bf16 v[136:139], v[60:63], v[20:23], v[136:139]
    v_mfma_f32_16x16x32_bf16 v[152:155], v[60:63], v[24:27], v[152:155]
    ds_read_b64_tr_b16 v[108:109], v16 offset:8192
    v_mfma_f32_16x16x32_bf16 v[168:171], v[60:63], v[28:31], v[168:171]
    v_mfma_f32_16x16x32_bf16 v[184:187], v[60:63], v[32:35], v[184:187]
    ds_read_b128 v[88:91], v13 offset:10240
    v_mfma_f32_16x16x32_bf16 v[200:203], v[60:63], v[36:39], v[200:203]
    v_mfma_f32_16x16x32_bf16 v[216:219], v[60:63], v[40:43], v[216:219]
    ds_read_b64_tr_b16 v[110:111], v16 offset:9216
    v_mfma_f32_16x16x32_bf16 v[232:235], v[60:63], v[44:47], v[232:235]
    v_mfma_f32_16x16x32_bf16 v[248:251], v[60:63], v[48:51], v[248:251]
    ds_read_b128 v[92:95], v13 offset:12288
    v_mfma_f32_16x16x32_bf16 v[140:143], v[64:67], v[20:23], v[140:143]
    v_mfma_f32_16x16x32_bf16 v[156:159], v[64:67], v[24:27], v[156:159]
    ds_read_b64_tr_b16 v[112:113], v17 offset:8192
    v_mfma_f32_16x16x32_bf16 v[172:175], v[64:67], v[28:31], v[172:175]
    v_mfma_f32_16x16x32_bf16 v[188:191], v[64:67], v[32:35], v[188:191]
    ds_read_b128 v[96:99], v13 offset:14336
    v_mfma_f32_16x16x32_bf16 v[204:207], v[64:67], v[36:39], v[204:207]
    v_mfma_f32_16x16x32_bf16 v[220:223], v[64:67], v[40:43], v[220:223]
    ds_read_b64_tr_b16 v[114:115], v17 offset:9216
    v_mfma_f32_16x16x32_bf16 v[236:239], v[64:67], v[44:47], v[236:239]
    v_mfma_f32_16x16x32_bf16 v[252:255], v[64:67], v[48:51], v[252:255]
    s_waitcnt lgkmcnt(0)
    v_mfma_f32_16x16x32_bf16 v[128:131], v[100:103], v[68:71], v[128:131]
    v_mfma_f32_16x16x32_bf16 v[144:147], v[100:103], v[72:75], v[144:147]
    v_mfma_f32_16x16x32_bf16 v[160:163], v[100:103], v[76:79], v[160:163]
    v_mfma_f32_16x16x32_bf16 v[176:179], v[100:103], v[80:83], v[176:179]
    v_mfma_f32_16x16x32_bf16 v[192:195], v[100:103], v[84:87], v[192:195]
    v_mfma_f32_16x16x32_bf16 v[208:211], v[100:103], v[88:91], v[208:211]
    v_mfma_f32_16x16x32_bf16 v[224:227], v[100:103], v[92:95], v[224:227]
    v_mfma_f32_16x16x32_bf16 v[240:243], v[100:103], v[96:99], v[240:243]
    v_mfma_f32_16x16x32_bf16 v[132:135], v[104:107], v[68:71], v[132:135]
    v_mfma_f32_16x16x32_bf16 v[148:151], v[104:107], v[72:75], v[148:151]
    v_mfma_f32_16x16x32_bf16 v[164:167], v[104:107], v[76:79], v[164:167]
    v_mfma_f32_16x16x32_bf16 v[180:183], v[104:107], v[80:83], v[180:183]
    v_mfma_f32_16x16x32_bf16 v[196:199], v[104:107], v[84:87], v[196:199]
    v_mfma_f32_16x16x32_bf16 v[212:215], v[104:107], v[88:91], v[212:215]
    v_mfma_f32_16x16x32_bf16 v[228:231], v[104:107], v[92:95], v[228:231]
    v_mfma_f32_16x16x32_bf16 v[244:247], v[104:107], v[96:99], v[244:247]
    v_mfma_f32_16x16x32_bf16 v[136:139], v[108:111], v[68:71], v[136:139]
    v_mfma_f32_16x16x32_bf16 v[152:155], v[108:111], v[72:75], v[152:155]
    v_mfma_f32_16x16x32_bf16 v[168:171], v[108:111], v[76:79], v[168:171]
    v_mfma_f32_16x16x32_bf16 v[184:187], v[108:111], v[80:83], v[184:187]
    v_mfma_f32_16x16x32_bf16 v[200:203], v[108:111], v[84:87], v[200:203]
    v_mfma_f32_16x16x32_bf16 v[216:219], v[108:111], v[88:91], v[216:219]
    v_mfma_f32_16x16x32_bf16 v[232:235], v[108:111], v[92:95], v[232:235]
    v_mfma_f32_16x16x32_bf16 v[248:251], v[108:111], v[96:99], v[248:251]
    v_mfma_f32_16x16x32_bf16 v[140:143], v[112:115], v[68:71], v[140:143]
    v_mfma_f32_16x16x32_bf16 v[156:159], v[112:115], v[72:75], v[156:159]
    v_mfma_f32_16x16x32_bf16 v[172:175], v[112:115], v[76:79], v[172:175]
    v_mfma_f32_16x16x32_bf16 v[188:191], v[112:115], v[80:83], v[188:191]
    v_mfma_f32_16x16x32_bf16 v[204:207], v[112:115], v[84:87], v[204:207]
    v_mfma_f32_16x16x32_bf16 v[220:223], v[112:115], v[88:91], v[220:223]
    v_mfma_f32_16x16x32_bf16 v[236:239], v[112:115], v[92:95], v[236:239]
    v_mfma_f32_16x16x32_bf16 v[252:255], v[112:115], v[96:99], v[252:255]
    s_and_b32 s40, s31, 1
    s_lshr_b32 s41, s31, 1
    s_lshl_b32 s42, s22, 4
    s_lshl_b32 s43, s40, 3
    s_add_u32 s42, s42, s43
    s_mul_i32 s42, s42, 112
    s_lshl_b32 s43, s23, 2
    s_add_u32 s42, s42, s43
    s_lshl_b32 s43, s41, 1
    s_add_u32 s42, s42, s43
    s_lshl_b32 s42, s42, 10
    s_mov_b32 s44, 3216550459
    s_mov_b32 s45, 3216550459
    s_mov_b32 s46, 1065353216
    s_mov_b32 s47, 1065353216
    v_lshlrev_b32 v4, 4, v2
    s_nop 7
    v_pk_mul_f32 v[20:21], v[128:129], s[44:45]
    v_pk_mul_f32 v[22:23], v[130:131], s[44:45]
    v_pk_mul_f32 v[24:25], v[132:133], s[44:45]
    v_pk_mul_f32 v[26:27], v[134:135], s[44:45]
    v_exp_f32 v20, v20
    v_exp_f32 v21, v21
    v_exp_f32 v22, v22
    v_exp_f32 v23, v23
    v_exp_f32 v24, v24
    v_exp_f32 v25, v25
    v_exp_f32 v26, v26
    v_exp_f32 v27, v27
    v_pk_add_f32 v[20:21], v[20:21], s[46:47]
    v_pk_add_f32 v[22:23], v[22:23], s[46:47]
    v_pk_add_f32 v[24:25], v[24:25], s[46:47]
    v_pk_add_f32 v[26:27], v[26:27], s[46:47]
    v_rcp_f32 v20, v20
    v_rcp_f32 v21, v21
    v_rcp_f32 v22, v22
    v_rcp_f32 v23, v23
    v_rcp_f32 v24, v24
    v_rcp_f32 v25, v25
    v_rcp_f32 v26, v26
    v_rcp_f32 v27, v27
    v_pk_mul_f32 v[20:21], v[20:21], v[128:129]
    v_pk_mul_f32 v[22:23], v[22:23], v[130:131]
    v_pk_mul_f32 v[24:25], v[24:25], v[132:133]
    v_pk_mul_f32 v[26:27], v[26:27], v[134:135]
    v_cvt_pk_bf16_f32 v28, v20, v21
    v_cvt_pk_bf16_f32 v29, v22, v23
    v_cvt_pk_bf16_f32 v30, v24, v25
    v_cvt_pk_bf16_f32 v31, v26, v27
    s_add_u32 s43, s42, 0
    buffer_store_dwordx4 v[28:31], v4, s[24:27], s43 offen sc1
    v_pk_mul_f32 v[36:37], v[136:137], s[44:45]
    v_pk_mul_f32 v[38:39], v[138:139], s[44:45]
    v_pk_mul_f32 v[40:41], v[140:141], s[44:45]
    v_pk_mul_f32 v[42:43], v[142:143], s[44:45]
    v_exp_f32 v36, v36
    v_exp_f32 v37, v37
    v_exp_f32 v38, v38
    v_exp_f32 v39, v39
    v_exp_f32 v40, v40
    v_exp_f32 v41, v41
    v_exp_f32 v42, v42
    v_exp_f32 v43, v43
    v_pk_add_f32 v[36:37], v[36:37], s[46:47]
    v_pk_add_f32 v[38:39], v[38:39], s[46:47]
    v_pk_add_f32 v[40:41], v[40:41], s[46:47]
    v_pk_add_f32 v[42:43], v[42:43], s[46:47]
    v_rcp_f32 v36, v36
    v_rcp_f32 v37, v37
    v_rcp_f32 v38, v38
    v_rcp_f32 v39, v39
    v_rcp_f32 v40, v40
    v_rcp_f32 v41, v41
    v_rcp_f32 v42, v42
    v_rcp_f32 v43, v43
    v_pk_mul_f32 v[36:37], v[36:37], v[136:137]
    v_pk_mul_f32 v[38:39], v[38:39], v[138:139]
    v_pk_mul_f32 v[40:41], v[40:41], v[140:141]
    v_pk_mul_f32 v[42:43], v[42:43], v[142:143]
    v_cvt_pk_bf16_f32 v44, v36, v37
    v_cvt_pk_bf16_f32 v45, v38, v39
    v_cvt_pk_bf16_f32 v46, v40, v41
    v_cvt_pk_bf16_f32 v47, v42, v43
    s_add_u32 s43, s42, 1024
    buffer_store_dwordx4 v[44:47], v4, s[24:27], s43 offen sc1
    v_pk_mul_f32 v[20:21], v[144:145], s[44:45]
    v_pk_mul_f32 v[22:23], v[146:147], s[44:45]
    v_pk_mul_f32 v[24:25], v[148:149], s[44:45]
    v_pk_mul_f32 v[26:27], v[150:151], s[44:45]
    v_exp_f32 v20, v20
    v_exp_f32 v21, v21
    v_exp_f32 v22, v22
    v_exp_f32 v23, v23
    v_exp_f32 v24, v24
    v_exp_f32 v25, v25
    v_exp_f32 v26, v26
    v_exp_f32 v27, v27
    v_pk_add_f32 v[20:21], v[20:21], s[46:47]
    v_pk_add_f32 v[22:23], v[22:23], s[46:47]
    v_pk_add_f32 v[24:25], v[24:25], s[46:47]
    v_pk_add_f32 v[26:27], v[26:27], s[46:47]
    v_rcp_f32 v20, v20
    v_rcp_f32 v21, v21
    v_rcp_f32 v22, v22
    v_rcp_f32 v23, v23
    v_rcp_f32 v24, v24
    v_rcp_f32 v25, v25
    v_rcp_f32 v26, v26
    v_rcp_f32 v27, v27
    v_pk_mul_f32 v[20:21], v[20:21], v[144:145]
    v_pk_mul_f32 v[22:23], v[22:23], v[146:147]
    v_pk_mul_f32 v[24:25], v[24:25], v[148:149]
    v_pk_mul_f32 v[26:27], v[26:27], v[150:151]
    v_cvt_pk_bf16_f32 v28, v20, v21
    v_cvt_pk_bf16_f32 v29, v22, v23
    v_cvt_pk_bf16_f32 v30, v24, v25
    v_cvt_pk_bf16_f32 v31, v26, v27
    s_add_u32 s43, s42, 114688
    buffer_store_dwordx4 v[28:31], v4, s[24:27], s43 offen sc1
    v_pk_mul_f32 v[36:37], v[152:153], s[44:45]
    v_pk_mul_f32 v[38:39], v[154:155], s[44:45]
    v_pk_mul_f32 v[40:41], v[156:157], s[44:45]
    v_pk_mul_f32 v[42:43], v[158:159], s[44:45]
    v_exp_f32 v36, v36
    v_exp_f32 v37, v37
    v_exp_f32 v38, v38
    v_exp_f32 v39, v39
    v_exp_f32 v40, v40
    v_exp_f32 v41, v41
    v_exp_f32 v42, v42
    v_exp_f32 v43, v43
    v_pk_add_f32 v[36:37], v[36:37], s[46:47]
    v_pk_add_f32 v[38:39], v[38:39], s[46:47]
    v_pk_add_f32 v[40:41], v[40:41], s[46:47]
    v_pk_add_f32 v[42:43], v[42:43], s[46:47]
    v_rcp_f32 v36, v36
    v_rcp_f32 v37, v37
    v_rcp_f32 v38, v38
    v_rcp_f32 v39, v39
    v_rcp_f32 v40, v40
    v_rcp_f32 v41, v41
    v_rcp_f32 v42, v42
    v_rcp_f32 v43, v43
    v_pk_mul_f32 v[36:37], v[36:37], v[152:153]
    v_pk_mul_f32 v[38:39], v[38:39], v[154:155]
    v_pk_mul_f32 v[40:41], v[40:41], v[156:157]
    v_pk_mul_f32 v[42:43], v[42:43], v[158:159]
    v_cvt_pk_bf16_f32 v44, v36, v37
    v_cvt_pk_bf16_f32 v45, v38, v39
    v_cvt_pk_bf16_f32 v46, v40, v41
    v_cvt_pk_bf16_f32 v47, v42, v43
    s_add_u32 s43, s42, 115712
    buffer_store_dwordx4 v[44:47], v4, s[24:27], s43 offen sc1
    v_pk_mul_f32 v[20:21], v[160:161], s[44:45]
    v_pk_mul_f32 v[22:23], v[162:163], s[44:45]
    v_pk_mul_f32 v[24:25], v[164:165], s[44:45]
    v_pk_mul_f32 v[26:27], v[166:167], s[44:45]
    v_exp_f32 v20, v20
    v_exp_f32 v21, v21
    v_exp_f32 v22, v22
    v_exp_f32 v23, v23
    v_exp_f32 v24, v24
    v_exp_f32 v25, v25
    v_exp_f32 v26, v26
    v_exp_f32 v27, v27
    v_pk_add_f32 v[20:21], v[20:21], s[46:47]
    v_pk_add_f32 v[22:23], v[22:23], s[46:47]
    v_pk_add_f32 v[24:25], v[24:25], s[46:47]
    v_pk_add_f32 v[26:27], v[26:27], s[46:47]
    v_rcp_f32 v20, v20
    v_rcp_f32 v21, v21
    v_rcp_f32 v22, v22
    v_rcp_f32 v23, v23
    v_rcp_f32 v24, v24
    v_rcp_f32 v25, v25
    v_rcp_f32 v26, v26
    v_rcp_f32 v27, v27
    v_pk_mul_f32 v[20:21], v[20:21], v[160:161]
    v_pk_mul_f32 v[22:23], v[22:23], v[162:163]
    v_pk_mul_f32 v[24:25], v[24:25], v[164:165]
    v_pk_mul_f32 v[26:27], v[26:27], v[166:167]
    v_cvt_pk_bf16_f32 v28, v20, v21
    v_cvt_pk_bf16_f32 v29, v22, v23
    v_cvt_pk_bf16_f32 v30, v24, v25
    v_cvt_pk_bf16_f32 v31, v26, v27
    s_add_u32 s43, s42, 229376
    buffer_store_dwordx4 v[28:31], v4, s[24:27], s43 offen sc1
    v_pk_mul_f32 v[36:37], v[168:169], s[44:45]
    v_pk_mul_f32 v[38:39], v[170:171], s[44:45]
    v_pk_mul_f32 v[40:41], v[172:173], s[44:45]
    v_pk_mul_f32 v[42:43], v[174:175], s[44:45]
    v_exp_f32 v36, v36
    v_exp_f32 v37, v37
    v_exp_f32 v38, v38
    v_exp_f32 v39, v39
    v_exp_f32 v40, v40
    v_exp_f32 v41, v41
    v_exp_f32 v42, v42
    v_exp_f32 v43, v43
    v_pk_add_f32 v[36:37], v[36:37], s[46:47]
    v_pk_add_f32 v[38:39], v[38:39], s[46:47]
    v_pk_add_f32 v[40:41], v[40:41], s[46:47]
    v_pk_add_f32 v[42:43], v[42:43], s[46:47]
    v_rcp_f32 v36, v36
    v_rcp_f32 v37, v37
    v_rcp_f32 v38, v38
    v_rcp_f32 v39, v39
    v_rcp_f32 v40, v40
    v_rcp_f32 v41, v41
    v_rcp_f32 v42, v42
    v_rcp_f32 v43, v43
    v_pk_mul_f32 v[36:37], v[36:37], v[168:169]
    v_pk_mul_f32 v[38:39], v[38:39], v[170:171]
    v_pk_mul_f32 v[40:41], v[40:41], v[172:173]
    v_pk_mul_f32 v[42:43], v[42:43], v[174:175]
    v_cvt_pk_bf16_f32 v44, v36, v37
    v_cvt_pk_bf16_f32 v45, v38, v39
    v_cvt_pk_bf16_f32 v46, v40, v41
    v_cvt_pk_bf16_f32 v47, v42, v43
    s_add_u32 s43, s42, 230400
    buffer_store_dwordx4 v[44:47], v4, s[24:27], s43 offen sc1
    v_pk_mul_f32 v[20:21], v[176:177], s[44:45]
    v_pk_mul_f32 v[22:23], v[178:179], s[44:45]
    v_pk_mul_f32 v[24:25], v[180:181], s[44:45]
    v_pk_mul_f32 v[26:27], v[182:183], s[44:45]
    v_exp_f32 v20, v20
    v_exp_f32 v21, v21
    v_exp_f32 v22, v22
    v_exp_f32 v23, v23
    v_exp_f32 v24, v24
    v_exp_f32 v25, v25
    v_exp_f32 v26, v26
    v_exp_f32 v27, v27
    v_pk_add_f32 v[20:21], v[20:21], s[46:47]
    v_pk_add_f32 v[22:23], v[22:23], s[46:47]
    v_pk_add_f32 v[24:25], v[24:25], s[46:47]
    v_pk_add_f32 v[26:27], v[26:27], s[46:47]
    v_rcp_f32 v20, v20
    v_rcp_f32 v21, v21
    v_rcp_f32 v22, v22
    v_rcp_f32 v23, v23
    v_rcp_f32 v24, v24
    v_rcp_f32 v25, v25
    v_rcp_f32 v26, v26
    v_rcp_f32 v27, v27
    v_pk_mul_f32 v[20:21], v[20:21], v[176:177]
    v_pk_mul_f32 v[22:23], v[22:23], v[178:179]
    v_pk_mul_f32 v[24:25], v[24:25], v[180:181]
    v_pk_mul_f32 v[26:27], v[26:27], v[182:183]
    v_cvt_pk_bf16_f32 v28, v20, v21
    v_cvt_pk_bf16_f32 v29, v22, v23
    v_cvt_pk_bf16_f32 v30, v24, v25
    v_cvt_pk_bf16_f32 v31, v26, v27
    s_add_u32 s43, s42, 344064
    buffer_store_dwordx4 v[28:31], v4, s[24:27], s43 offen sc1
    v_pk_mul_f32 v[36:37], v[184:185], s[44:45]
    v_pk_mul_f32 v[38:39], v[186:187], s[44:45]
    v_pk_mul_f32 v[40:41], v[188:189], s[44:45]
    v_pk_mul_f32 v[42:43], v[190:191], s[44:45]
    v_exp_f32 v36, v36
    v_exp_f32 v37, v37
    v_exp_f32 v38, v38
    v_exp_f32 v39, v39
    v_exp_f32 v40, v40
    v_exp_f32 v41, v41
    v_exp_f32 v42, v42
    v_exp_f32 v43, v43
    v_pk_add_f32 v[36:37], v[36:37], s[46:47]
    v_pk_add_f32 v[38:39], v[38:39], s[46:47]
    v_pk_add_f32 v[40:41], v[40:41], s[46:47]
    v_pk_add_f32 v[42:43], v[42:43], s[46:47]
    v_rcp_f32 v36, v36
    v_rcp_f32 v37, v37
    v_rcp_f32 v38, v38
    v_rcp_f32 v39, v39
    v_rcp_f32 v40, v40
    v_rcp_f32 v41, v41
    v_rcp_f32 v42, v42
    v_rcp_f32 v43, v43
    v_pk_mul_f32 v[36:37], v[36:37], v[184:185]
    v_pk_mul_f32 v[38:39], v[38:39], v[186:187]
    v_pk_mul_f32 v[40:41], v[40:41], v[188:189]
    v_pk_mul_f32 v[42:43], v[42:43], v[190:191]
    v_cvt_pk_bf16_f32 v44, v36, v37
    v_cvt_pk_bf16_f32 v45, v38, v39
    v_cvt_pk_bf16_f32 v46, v40, v41
    v_cvt_pk_bf16_f32 v47, v42, v43
    s_add_u32 s43, s42, 345088
    buffer_store_dwordx4 v[44:47], v4, s[24:27], s43 offen sc1
    v_pk_mul_f32 v[20:21], v[192:193], s[44:45]
    v_pk_mul_f32 v[22:23], v[194:195], s[44:45]
    v_pk_mul_f32 v[24:25], v[196:197], s[44:45]
    v_pk_mul_f32 v[26:27], v[198:199], s[44:45]
    v_exp_f32 v20, v20
    v_exp_f32 v21, v21
    v_exp_f32 v22, v22
    v_exp_f32 v23, v23
    v_exp_f32 v24, v24
    v_exp_f32 v25, v25
    v_exp_f32 v26, v26
    v_exp_f32 v27, v27
    v_pk_add_f32 v[20:21], v[20:21], s[46:47]
    v_pk_add_f32 v[22:23], v[22:23], s[46:47]
    v_pk_add_f32 v[24:25], v[24:25], s[46:47]
    v_pk_add_f32 v[26:27], v[26:27], s[46:47]
    v_rcp_f32 v20, v20
    v_rcp_f32 v21, v21
    v_rcp_f32 v22, v22
    v_rcp_f32 v23, v23
    v_rcp_f32 v24, v24
    v_rcp_f32 v25, v25
    v_rcp_f32 v26, v26
    v_rcp_f32 v27, v27
    v_pk_mul_f32 v[20:21], v[20:21], v[192:193]
    v_pk_mul_f32 v[22:23], v[22:23], v[194:195]
    v_pk_mul_f32 v[24:25], v[24:25], v[196:197]
    v_pk_mul_f32 v[26:27], v[26:27], v[198:199]
    v_cvt_pk_bf16_f32 v28, v20, v21
    v_cvt_pk_bf16_f32 v29, v22, v23
    v_cvt_pk_bf16_f32 v30, v24, v25
    v_cvt_pk_bf16_f32 v31, v26, v27
    s_add_u32 s43, s42, 458752
    buffer_store_dwordx4 v[28:31], v4, s[24:27], s43 offen sc1
    v_pk_mul_f32 v[36:37], v[200:201], s[44:45]
    v_pk_mul_f32 v[38:39], v[202:203], s[44:45]
    v_pk_mul_f32 v[40:41], v[204:205], s[44:45]
    v_pk_mul_f32 v[42:43], v[206:207], s[44:45]
    v_exp_f32 v36, v36
    v_exp_f32 v37, v37
    v_exp_f32 v38, v38
    v_exp_f32 v39, v39
    v_exp_f32 v40, v40
    v_exp_f32 v41, v41
    v_exp_f32 v42, v42
    v_exp_f32 v43, v43
    v_pk_add_f32 v[36:37], v[36:37], s[46:47]
    v_pk_add_f32 v[38:39], v[38:39], s[46:47]
    v_pk_add_f32 v[40:41], v[40:41], s[46:47]
    v_pk_add_f32 v[42:43], v[42:43], s[46:47]
    v_rcp_f32 v36, v36
    v_rcp_f32 v37, v37
    v_rcp_f32 v38, v38
    v_rcp_f32 v39, v39
    v_rcp_f32 v40, v40
    v_rcp_f32 v41, v41
    v_rcp_f32 v42, v42
    v_rcp_f32 v43, v43
    v_pk_mul_f32 v[36:37], v[36:37], v[200:201]
    v_pk_mul_f32 v[38:39], v[38:39], v[202:203]
    v_pk_mul_f32 v[40:41], v[40:41], v[204:205]
    v_pk_mul_f32 v[42:43], v[42:43], v[206:207]
    v_cvt_pk_bf16_f32 v44, v36, v37
    v_cvt_pk_bf16_f32 v45, v38, v39
    v_cvt_pk_bf16_f32 v46, v40, v41
    v_cvt_pk_bf16_f32 v47, v42, v43
    s_add_u32 s43, s42, 459776
    buffer_store_dwordx4 v[44:47], v4, s[24:27], s43 offen sc1
    v_pk_mul_f32 v[20:21], v[208:209], s[44:45]
    v_pk_mul_f32 v[22:23], v[210:211], s[44:45]
    v_pk_mul_f32 v[24:25], v[212:213], s[44:45]
    v_pk_mul_f32 v[26:27], v[214:215], s[44:45]
    v_exp_f32 v20, v20
    v_exp_f32 v21, v21
    v_exp_f32 v22, v22
    v_exp_f32 v23, v23
    v_exp_f32 v24, v24
    v_exp_f32 v25, v25
    v_exp_f32 v26, v26
    v_exp_f32 v27, v27
    v_pk_add_f32 v[20:21], v[20:21], s[46:47]
    v_pk_add_f32 v[22:23], v[22:23], s[46:47]
    v_pk_add_f32 v[24:25], v[24:25], s[46:47]
    v_pk_add_f32 v[26:27], v[26:27], s[46:47]
    v_rcp_f32 v20, v20
    v_rcp_f32 v21, v21
    v_rcp_f32 v22, v22
    v_rcp_f32 v23, v23
    v_rcp_f32 v24, v24
    v_rcp_f32 v25, v25
    v_rcp_f32 v26, v26
    v_rcp_f32 v27, v27
    v_pk_mul_f32 v[20:21], v[20:21], v[208:209]
    v_pk_mul_f32 v[22:23], v[22:23], v[210:211]
    v_pk_mul_f32 v[24:25], v[24:25], v[212:213]
    v_pk_mul_f32 v[26:27], v[26:27], v[214:215]
    v_cvt_pk_bf16_f32 v28, v20, v21
    v_cvt_pk_bf16_f32 v29, v22, v23
    v_cvt_pk_bf16_f32 v30, v24, v25
    v_cvt_pk_bf16_f32 v31, v26, v27
    s_add_u32 s43, s42, 573440
    buffer_store_dwordx4 v[28:31], v4, s[24:27], s43 offen sc1
    v_pk_mul_f32 v[36:37], v[216:217], s[44:45]
    v_pk_mul_f32 v[38:39], v[218:219], s[44:45]
    v_pk_mul_f32 v[40:41], v[220:221], s[44:45]
    v_pk_mul_f32 v[42:43], v[222:223], s[44:45]
    v_exp_f32 v36, v36
    v_exp_f32 v37, v37
    v_exp_f32 v38, v38
    v_exp_f32 v39, v39
    v_exp_f32 v40, v40
    v_exp_f32 v41, v41
    v_exp_f32 v42, v42
    v_exp_f32 v43, v43
    v_pk_add_f32 v[36:37], v[36:37], s[46:47]
    v_pk_add_f32 v[38:39], v[38:39], s[46:47]
    v_pk_add_f32 v[40:41], v[40:41], s[46:47]
    v_pk_add_f32 v[42:43], v[42:43], s[46:47]
    v_rcp_f32 v36, v36
    v_rcp_f32 v37, v37
    v_rcp_f32 v38, v38
    v_rcp_f32 v39, v39
    v_rcp_f32 v40, v40
    v_rcp_f32 v41, v41
    v_rcp_f32 v42, v42
    v_rcp_f32 v43, v43
    v_pk_mul_f32 v[36:37], v[36:37], v[216:217]
    v_pk_mul_f32 v[38:39], v[38:39], v[218:219]
    v_pk_mul_f32 v[40:41], v[40:41], v[220:221]
    v_pk_mul_f32 v[42:43], v[42:43], v[222:223]
    v_cvt_pk_bf16_f32 v44, v36, v37
    v_cvt_pk_bf16_f32 v45, v38, v39
    v_cvt_pk_bf16_f32 v46, v40, v41
    v_cvt_pk_bf16_f32 v47, v42, v43
    s_add_u32 s43, s42, 574464
    buffer_store_dwordx4 v[44:47], v4, s[24:27], s43 offen sc1
    v_pk_mul_f32 v[20:21], v[224:225], s[44:45]
    v_pk_mul_f32 v[22:23], v[226:227], s[44:45]
    v_pk_mul_f32 v[24:25], v[228:229], s[44:45]
    v_pk_mul_f32 v[26:27], v[230:231], s[44:45]
    v_exp_f32 v20, v20
    v_exp_f32 v21, v21
    v_exp_f32 v22, v22
    v_exp_f32 v23, v23
    v_exp_f32 v24, v24
    v_exp_f32 v25, v25
    v_exp_f32 v26, v26
    v_exp_f32 v27, v27
    v_pk_add_f32 v[20:21], v[20:21], s[46:47]
    v_pk_add_f32 v[22:23], v[22:23], s[46:47]
    v_pk_add_f32 v[24:25], v[24:25], s[46:47]
    v_pk_add_f32 v[26:27], v[26:27], s[46:47]
    v_rcp_f32 v20, v20
    v_rcp_f32 v21, v21
    v_rcp_f32 v22, v22
    v_rcp_f32 v23, v23
    v_rcp_f32 v24, v24
    v_rcp_f32 v25, v25
    v_rcp_f32 v26, v26
    v_rcp_f32 v27, v27
    v_pk_mul_f32 v[20:21], v[20:21], v[224:225]
    v_pk_mul_f32 v[22:23], v[22:23], v[226:227]
    v_pk_mul_f32 v[24:25], v[24:25], v[228:229]
    v_pk_mul_f32 v[26:27], v[26:27], v[230:231]
    v_cvt_pk_bf16_f32 v28, v20, v21
    v_cvt_pk_bf16_f32 v29, v22, v23
    v_cvt_pk_bf16_f32 v30, v24, v25
    v_cvt_pk_bf16_f32 v31, v26, v27
    s_add_u32 s43, s42, 688128
    buffer_store_dwordx4 v[28:31], v4, s[24:27], s43 offen sc1
    v_pk_mul_f32 v[36:37], v[232:233], s[44:45]
    v_pk_mul_f32 v[38:39], v[234:235], s[44:45]
    v_pk_mul_f32 v[40:41], v[236:237], s[44:45]
    v_pk_mul_f32 v[42:43], v[238:239], s[44:45]
    v_exp_f32 v36, v36
    v_exp_f32 v37, v37
    v_exp_f32 v38, v38
    v_exp_f32 v39, v39
    v_exp_f32 v40, v40
    v_exp_f32 v41, v41
    v_exp_f32 v42, v42
    v_exp_f32 v43, v43
    v_pk_add_f32 v[36:37], v[36:37], s[46:47]
    v_pk_add_f32 v[38:39], v[38:39], s[46:47]
    v_pk_add_f32 v[40:41], v[40:41], s[46:47]
    v_pk_add_f32 v[42:43], v[42:43], s[46:47]
    v_rcp_f32 v36, v36
    v_rcp_f32 v37, v37
    v_rcp_f32 v38, v38
    v_rcp_f32 v39, v39
    v_rcp_f32 v40, v40
    v_rcp_f32 v41, v41
    v_rcp_f32 v42, v42
    v_rcp_f32 v43, v43
    v_pk_mul_f32 v[36:37], v[36:37], v[232:233]
    v_pk_mul_f32 v[38:39], v[38:39], v[234:235]
    v_pk_mul_f32 v[40:41], v[40:41], v[236:237]
    v_pk_mul_f32 v[42:43], v[42:43], v[238:239]
    v_cvt_pk_bf16_f32 v44, v36, v37
    v_cvt_pk_bf16_f32 v45, v38, v39
    v_cvt_pk_bf16_f32 v46, v40, v41
    v_cvt_pk_bf16_f32 v47, v42, v43
    s_add_u32 s43, s42, 689152
    buffer_store_dwordx4 v[44:47], v4, s[24:27], s43 offen sc1
    v_pk_mul_f32 v[20:21], v[240:241], s[44:45]
    v_pk_mul_f32 v[22:23], v[242:243], s[44:45]
    v_pk_mul_f32 v[24:25], v[244:245], s[44:45]
    v_pk_mul_f32 v[26:27], v[246:247], s[44:45]
    v_exp_f32 v20, v20
    v_exp_f32 v21, v21
    v_exp_f32 v22, v22
    v_exp_f32 v23, v23
    v_exp_f32 v24, v24
    v_exp_f32 v25, v25
    v_exp_f32 v26, v26
    v_exp_f32 v27, v27
    v_pk_add_f32 v[20:21], v[20:21], s[46:47]
    v_pk_add_f32 v[22:23], v[22:23], s[46:47]
    v_pk_add_f32 v[24:25], v[24:25], s[46:47]
    v_pk_add_f32 v[26:27], v[26:27], s[46:47]
    v_rcp_f32 v20, v20
    v_rcp_f32 v21, v21
    v_rcp_f32 v22, v22
    v_rcp_f32 v23, v23
    v_rcp_f32 v24, v24
    v_rcp_f32 v25, v25
    v_rcp_f32 v26, v26
    v_rcp_f32 v27, v27
    v_pk_mul_f32 v[20:21], v[20:21], v[240:241]
    v_pk_mul_f32 v[22:23], v[22:23], v[242:243]
    v_pk_mul_f32 v[24:25], v[24:25], v[244:245]
    v_pk_mul_f32 v[26:27], v[26:27], v[246:247]
    v_cvt_pk_bf16_f32 v28, v20, v21
    v_cvt_pk_bf16_f32 v29, v22, v23
    v_cvt_pk_bf16_f32 v30, v24, v25
    v_cvt_pk_bf16_f32 v31, v26, v27
    s_add_u32 s43, s42, 802816
    buffer_store_dwordx4 v[28:31], v4, s[24:27], s43 offen sc1
    v_pk_mul_f32 v[36:37], v[248:249], s[44:45]
    v_pk_mul_f32 v[38:39], v[250:251], s[44:45]
    v_pk_mul_f32 v[40:41], v[252:253], s[44:45]
    v_pk_mul_f32 v[42:43], v[254:255], s[44:45]
    v_exp_f32 v36, v36
    v_exp_f32 v37, v37
    v_exp_f32 v38, v38
    v_exp_f32 v39, v39
    v_exp_f32 v40, v40
    v_exp_f32 v41, v41
    v_exp_f32 v42, v42
    v_exp_f32 v43, v43
    v_pk_add_f32 v[36:37], v[36:37], s[46:47]
    v_pk_add_f32 v[38:39], v[38:39], s[46:47]
    v_pk_add_f32 v[40:41], v[40:41], s[46:47]
    v_pk_add_f32 v[42:43], v[42:43], s[46:47]
    v_rcp_f32 v36, v36
    v_rcp_f32 v37, v37
    v_rcp_f32 v38, v38
    v_rcp_f32 v39, v39
    v_rcp_f32 v40, v40
    v_rcp_f32 v41, v41
    v_rcp_f32 v42, v42
    v_rcp_f32 v43, v43
    v_pk_mul_f32 v[36:37], v[36:37], v[248:249]
    v_pk_mul_f32 v[38:39], v[38:39], v[250:251]
    v_pk_mul_f32 v[40:41], v[40:41], v[252:253]
    v_pk_mul_f32 v[42:43], v[42:43], v[254:255]
    v_cvt_pk_bf16_f32 v44, v36, v37
    v_cvt_pk_bf16_f32 v45, v38, v39
    v_cvt_pk_bf16_f32 v46, v40, v41
    v_cvt_pk_bf16_f32 v47, v42, v43
    s_add_u32 s43, s42, 803840
    buffer_store_dwordx4 v[44:47], v4, s[24:27], s43 offen sc1
    s_mov_b32 s34, 1
    s_branch F_p2cons
F_fft0:
    s_waitcnt lgkmcnt(0)
    s_add_u32 s96, s8, 58720256
    s_addc_u32 s97, s9, 0
    s_mov_b32 s98, 40960
    s_mov_b32 s99, 0x20000
F_fft:
    s_waitcnt lgkmcnt(0)
    s_load_dwordx2 s[4:5], s[0:1], 0
    s_load_dwordx2 s[6:7], s[0:1], 48
    s_sub_u32 s22, s21, 28
    s_lshl_b32 s22, s22, 3
    s_add_u32 s22, s22, s20
    s_lshl_b32 s22, s22, 3
    s_waitcnt lgkmcnt(0)
    s_mov_b32 s12, s4
    s_mov_b32 s13, s5
    s_mov_b32 s14, 4194304
    s_mov_b32 s15, 0x20000
    s_mov_b32 s16, s6
    s_mov_b32 s17, s7
    s_mov_b32 s18, 2048
    s_mov_b32 s19, 0x20000
    s_add_u32 s36, s8, 16777216
    s_addc_u32 s37, s9, 0
    s_mov_b32 s38, 4210688
    s_mov_b32 s39, 0x20000
    s_add_u32 s32, s8, 50331648
    s_addc_u32 s33, s9, 0
    s_mov_b32 s34, 8192
    s_mov_b32 s35, 0x20000
    s_load_dwordx2 s[4:5], s[0:1], 8
    s_load_dwordx2 s[6:7], s[0:1], 16
    v_mov_b32 v30, 0
    v_lshrrev_b32 v4, 7, v0
    v_and_b32 v5, 127, v0
    v_add_u32 v6, s22, v4
    v_lshlrev_b32 v6, 11, v6
    v_lshl_add_u32 v12, v5, 4, v6
    s_mov_b32 s50, 0
    s_mov_b32 s51, 524288
    s_mov_b32 s52, 1048576
    s_mov_b32 s53, 1572864
    s_mov_b32 s54, 2097152
    s_mov_b32 s55, 2621440
    s_mov_b32 s56, 3145728
    s_mov_b32 s57, 3670016
    buffer_load_dwordx4 v[32:35], v12, s[12:15], s50 offen
    buffer_load_dwordx4 v[36:39], v12, s[12:15], s51 offen
    buffer_load_dwordx4 v[40:43], v12, s[12:15], s52 offen
    buffer_load_dwordx4 v[44:47], v12, s[12:15], s53 offen
    buffer_load_dwordx4 v[48:51], v12, s[12:15], s54 offen
    buffer_load_dwordx4 v[52:55], v12, s[12:15], s55 offen
    buffer_load_dwordx4 v[56:59], v12, s[12:15], s56 offen
    buffer_load_dwordx4 v[60:63], v12, s[12:15], s57 offen
    v_lshlrev_b32 v6, 4, v5
    buffer_load_dwordx4 v[26:29], v6, s[16:19], 0 offen
    v_lshlrev_b32 v6, 14, v4
    v_and_b32 v7, 3, v5
    v_lshl_add_u32 v6, v7, 10, v6
    v_bfe_u32 v7, v5, 2, 2
    v_lshl_add_u32 v6, v7, 2, v6
    v_lshrrev_b32 v7, 4, v5
    v_and_b32 v8, 1, v5
    v_lshlrev_b32 v8, 2, v8
    v_xor_b32 v7, v7, v8
    v_xor_b32 v8, 0, v7
    v_lshl_add_u32 v8, v8, 4, v6
    v_add_u32 v13, 0, v8
    v_xor_b32 v8, 1, v7
    v_lshl_add_u32 v8, v8, 4, v6
    v_add_u32 v14, 256, v8
    v_xor_b32 v8, 2, v7
    v_lshl_add_u32 v8, v8, 4, v6
    v_add_u32 v15, 512, v8
    v_xor_b32 v8, 3, v7
    v_lshl_add_u32 v8, v8, 4, v6
    v_add_u32 v16, 768, v8
    s_and_b32 s40, s31, 1
    s_lshl_b32 s40, s40, 2
    v_lshrrev_b32 v7, 4, v2
    v_add_u32 v7, s40, v7
    v_lshlrev_b32 v8, 6, v4
    v_add_u32 v7, v7, v8
    v_lshlrev_b32 v7, 2, v7
    v_add_u32 v25, 133120, v7
    s_and_b32 s23, s31, 3
    s_lshr_b32 s26, s31, 2
    v_and_b32 v4, 31, v2
    v_lshrrev_b32 v5, 5, v2
    v_bfe_u32 v6, v4, 1, 3
    v_xor_b32 v6, v6, v5
    v_lshlrev_b32 v6, 4, v6
    v_lshl_add_u32 v6, v4, 7, v6
    s_lshl_b32 s40, s26, 15
    s_lshl_b32 s41, s23, 12
    s_add_u32 s40, s40, s41
    v_xor_b32 v7, 0, v6
    v_add_u32 v17, s40, v7
    v_xor_b32 v7, 32, v6
    v_add_u32 v18, s40, v7
    v_xor_b32 v7, 64, v6
    v_add_u32 v19, s40, v7
    v_xor_b32 v7, 96, v6
    v_add_u32 v20, s40, v7
    s_mul_i32 s27, s31, 8448
    s_add_u32 s27, s27, 65536
    s_cmp_eq_u32 s23, 0
    s_cbranch_scc1 P1_set0addr
    v_lshrrev_b32 v6, 4, v4
    v_lshlrev_b32 v6, 5, v6
    v_and_b32 v7, 15, v4
    v_add_u32 v6, v6, v7
    v_lshl_add_u32 v6, v5, 8, v6
    v_lshlrev_b32 v6, 2, v6
    v_add_u32 v21, s27, v6
    v_mov_b32 v22, v21
    s_branch P1_addrdone
P1_set0addr:
    v_lshrrev_b32 v6, 3, v4
    v_lshlrev_b32 v6, 5, v6
    v_and_b32 v7, 7, v4
    v_add_u32 v6, v6, v7
    v_lshl_add_u32 v6, v5, 9, v6
    v_lshlrev_b32 v6, 2, v6
    v_add_u32 v21, s27, v6
    v_sub_u32 v6, 32, v4
    v_lshrrev_b32 v7, 3, v6
    v_lshlrev_b32 v7, 5, v7
    v_and_b32 v6, 7, v6
    v_add3_u32 v6, v6, v7, 8
    v_lshlrev_b32 v7, 9, v5
    v_sub_u32 v6, v6, v7
    v_add_u32 v6, 512, v6
    v_lshlrev_b32 v6, 2, v6
    v_add_u32 v22, s27, v6
P1_addrdone:
    v_lshlrev_b32 v6, 4, v2
    v_add_u32 v23, s27, v6
    v_lshrrev_b32 v6, 3, v2
    v_lshlrev_b32 v6, 14, v6
    v_and_b32 v7, 7, v2
    v_lshl_add_u32 v24, v7, 4, v6
    s_sub_u32 s28, s23, 1
    s_and_b32 s28, s28, 3
    s_lshl_b32 s28, s28, 20
    v_and_b32 v4, 31, v2
    v_lshrrev_b32 v5, 5, v2
    v_lshlrev_b32 v5, 2, v5
    s_mov_b32 s40, 1023410176
    v_add_u32 v6, 0, v5
    v_mul_u32_u24 v6, v6, v4
    v_and_b32 v6, 31, v6
    v_cvt_f32_u32 v6, v6
    v_mul_f32 v6, s40, v6
    v_cos_f32 v7, v6
    v_sin_f32 v8, v6
    s_nop 0
    v_cvt_pk_bf16_f32 v104, v7, v8
    v_cvt_pk_bf16_f32 v120, -v8, v7
    v_add_u32 v6, 1, v5
    v_mul_u32_u24 v6, v6, v4
    v_and_b32 v6, 31, v6
    v_cvt_f32_u32 v6, v6
    v_mul_f32 v6, s40, v6
    v_cos_f32 v7, v6
    v_sin_f32 v8, v6
    s_nop 0
    v_cvt_pk_bf16_f32 v105, v7, v8
    v_cvt_pk_bf16_f32 v121, -v8, v7
    v_add_u32 v6, 2, v5
    v_mul_u32_u24 v6, v6, v4
    v_and_b32 v6, 31, v6
    v_cvt_f32_u32 v6, v6
    v_mul_f32 v6, s40, v6
    v_cos_f32 v7, v6
    v_sin_f32 v8, v6
    s_nop 0
    v_cvt_pk_bf16_f32 v106, v7, v8
    v_cvt_pk_bf16_f32 v122, -v8, v7
    v_add_u32 v6, 3, v5
    v_mul_u32_u24 v6, v6, v4
    v_and_b32 v6, 31, v6
    v_cvt_f32_u32 v6, v6
    v_mul_f32 v6, s40, v6
    v_cos_f32 v7, v6
    v_sin_f32 v8, v6
    s_nop 0
    v_cvt_pk_bf16_f32 v107, v7, v8
    v_cvt_pk_bf16_f32 v123, -v8, v7
    v_add_u32 v6, 8, v5
    v_mul_u32_u24 v6, v6, v4
    v_and_b32 v6, 31, v6
    v_cvt_f32_u32 v6, v6
    v_mul_f32 v6, s40, v6
    v_cos_f32 v7, v6
    v_sin_f32 v8, v6
    s_nop 0
    v_cvt_pk_bf16_f32 v108, v7, v8
    v_cvt_pk_bf16_f32 v124, -v8, v7
    v_add_u32 v6, 9, v5
    v_mul_u32_u24 v6, v6, v4
    v_and_b32 v6, 31, v6
    v_cvt_f32_u32 v6, v6
    v_mul_f32 v6, s40, v6
    v_cos_f32 v7, v6
    v_sin_f32 v8, v6
    s_nop 0
    v_cvt_pk_bf16_f32 v109, v7, v8
    v_cvt_pk_bf16_f32 v125, -v8, v7
    v_add_u32 v6, 10, v5
    v_mul_u32_u24 v6, v6, v4
    v_and_b32 v6, 31, v6
    v_cvt_f32_u32 v6, v6
    v_mul_f32 v6, s40, v6
    v_cos_f32 v7, v6
    v_sin_f32 v8, v6
    s_nop 0
    v_cvt_pk_bf16_f32 v110, v7, v8
    v_cvt_pk_bf16_f32 v126, -v8, v7
    v_add_u32 v6, 11, v5
    v_mul_u32_u24 v6, v6, v4
    v_and_b32 v6, 31, v6
    v_cvt_f32_u32 v6, v6
    v_mul_f32 v6, s40, v6
    v_cos_f32 v7, v6
    v_sin_f32 v8, v6
    s_nop 0
    v_cvt_pk_bf16_f32 v111, v7, v8
    v_cvt_pk_bf16_f32 v127, -v8, v7
    v_add_u32 v6, 16, v5
    v_mul_u32_u24 v6, v6, v4
    v_and_b32 v6, 31, v6
    v_cvt_f32_u32 v6, v6
    v_mul_f32 v6, s40, v6
    v_cos_f32 v7, v6
    v_sin_f32 v8, v6
    s_nop 0
    v_cvt_pk_bf16_f32 v112, v7, v8
    v_cvt_pk_bf16_f32 v128, -v8, v7
    v_add_u32 v6, 17, v5
    v_mul_u32_u24 v6, v6, v4
    v_and_b32 v6, 31, v6
    v_cvt_f32_u32 v6, v6
    v_mul_f32 v6, s40, v6
    v_cos_f32 v7, v6
    v_sin_f32 v8, v6
    s_nop 0
    v_cvt_pk_bf16_f32 v113, v7, v8
    v_cvt_pk_bf16_f32 v129, -v8, v7
    v_add_u32 v6, 18, v5
    v_mul_u32_u24 v6, v6, v4
    v_and_b32 v6, 31, v6
    v_cvt_f32_u32 v6, v6
    v_mul_f32 v6, s40, v6
    v_cos_f32 v7, v6
    v_sin_f32 v8, v6
    s_nop 0
    v_cvt_pk_bf16_f32 v114, v7, v8
    v_cvt_pk_bf16_f32 v130, -v8, v7
    v_add_u32 v6, 19, v5
    v_mul_u32_u24 v6, v6, v4
    v_and_b32 v6, 31, v6
    v_cvt_f32_u32 v6, v6
    v_mul_f32 v6, s40, v6
    v_cos_f32 v7, v6
    v_sin_f32 v8, v6
    s_nop 0
    v_cvt_pk_bf16_f32 v115, v7, v8
    v_cvt_pk_bf16_f32 v131, -v8, v7
    v_add_u32 v6, 24, v5
    v_mul_u32_u24 v6, v6, v4
    v_and_b32 v6, 31, v6
    v_cvt_f32_u32 v6, v6
    v_mul_f32 v6, s40, v6
    v_cos_f32 v7, v6
    v_sin_f32 v8, v6
    s_nop 0
    v_cvt_pk_bf16_f32 v116, v7, v8
    v_cvt_pk_bf16_f32 v132, -v8, v7
    v_add_u32 v6, 25, v5
    v_mul_u32_u24 v6, v6, v4
    v_and_b32 v6, 31, v6
    v_cvt_f32_u32 v6, v6
    v_mul_f32 v6, s40, v6
    v_cos_f32 v7, v6
    v_sin_f32 v8, v6
    s_nop 0
    v_cvt_pk_bf16_f32 v117, v7, v8
    v_cvt_pk_bf16_f32 v133, -v8, v7
    v_add_u32 v6, 26, v5
    v_mul_u32_u24 v6, v6, v4
    v_and_b32 v6, 31, v6
    v_cvt_f32_u32 v6, v6
    v_mul_f32 v6, s40, v6
    v_cos_f32 v7, v6
    v_sin_f32 v8, v6
    s_nop 0
    v_cvt_pk_bf16_f32 v118, v7, v8
    v_cvt_pk_bf16_f32 v134, -v8, v7
    v_add_u32 v6, 27, v5
    v_mul_u32_u24 v6, v6, v4
    v_and_b32 v6, 31, v6
    v_cvt_f32_u32 v6, v6
    v_mul_f32 v6, s40, v6
    v_cos_f32 v7, v6
    v_sin_f32 v8, v6
    s_nop 0
    v_cvt_pk_bf16_f32 v119, v7, v8
    v_cvt_pk_bf16_f32 v135, -v8, v7
    v_and_b32 v4, 31, v2
    v_lshrrev_b32 v5, 5, v2
    v_lshlrev_b32 v5, 2, v5
    s_mov_b32 s40, 981467136
    v_add_u32 v6, 0, v5
    v_mul_u32_u24 v6, v6, v4
    v_cvt_f32_u32 v6, v6
    v_mul_f32 v6, s40, v6
    v_cos_f32 v136, v6
    v_sin_f32 v152, v6
    v_add_u32 v6, 1, v5
    v_mul_u32_u24 v6, v6, v4
    v_cvt_f32_u32 v6, v6
    v_mul_f32 v6, s40, v6
    v_cos_f32 v137, v6
    v_sin_f32 v153, v6
    v_add_u32 v6, 2, v5
    v_mul_u32_u24 v6, v6, v4
    v_cvt_f32_u32 v6, v6
    v_mul_f32 v6, s40, v6
    v_cos_f32 v138, v6
    v_sin_f32 v154, v6
    v_add_u32 v6, 3, v5
    v_mul_u32_u24 v6, v6, v4
    v_cvt_f32_u32 v6, v6
    v_mul_f32 v6, s40, v6
    v_cos_f32 v139, v6
    v_sin_f32 v155, v6
    v_add_u32 v6, 8, v5
    v_mul_u32_u24 v6, v6, v4
    v_cvt_f32_u32 v6, v6
    v_mul_f32 v6, s40, v6
    v_cos_f32 v140, v6
    v_sin_f32 v156, v6
    v_add_u32 v6, 9, v5
    v_mul_u32_u24 v6, v6, v4
    v_cvt_f32_u32 v6, v6
    v_mul_f32 v6, s40, v6
    v_cos_f32 v141, v6
    v_sin_f32 v157, v6
    v_add_u32 v6, 10, v5
    v_mul_u32_u24 v6, v6, v4
    v_cvt_f32_u32 v6, v6
    v_mul_f32 v6, s40, v6
    v_cos_f32 v142, v6
    v_sin_f32 v158, v6
    v_add_u32 v6, 11, v5
    v_mul_u32_u24 v6, v6, v4
    v_cvt_f32_u32 v6, v6
    v_mul_f32 v6, s40, v6
    v_cos_f32 v143, v6
    v_sin_f32 v159, v6
    v_add_u32 v6, 16, v5
    v_mul_u32_u24 v6, v6, v4
    v_cvt_f32_u32 v6, v6
    v_mul_f32 v6, s40, v6
    v_cos_f32 v144, v6
    v_sin_f32 v160, v6
    v_add_u32 v6, 17, v5
    v_mul_u32_u24 v6, v6, v4
    v_cvt_f32_u32 v6, v6
    v_mul_f32 v6, s40, v6
    v_cos_f32 v145, v6
    v_sin_f32 v161, v6
    v_add_u32 v6, 18, v5
    v_mul_u32_u24 v6, v6, v4
    v_cvt_f32_u32 v6, v6
    v_mul_f32 v6, s40, v6
    v_cos_f32 v146, v6
    v_sin_f32 v162, v6
    v_add_u32 v6, 19, v5
    v_mul_u32_u24 v6, v6, v4
    v_cvt_f32_u32 v6, v6
    v_mul_f32 v6, s40, v6
    v_cos_f32 v147, v6
    v_sin_f32 v163, v6
    v_add_u32 v6, 24, v5
    v_mul_u32_u24 v6, v6, v4
    v_cvt_f32_u32 v6, v6
    v_mul_f32 v6, s40, v6
    v_cos_f32 v148, v6
    v_sin_f32 v164, v6
    v_add_u32 v6, 25, v5
    v_mul_u32_u24 v6, v6, v4
    v_cvt_f32_u32 v6, v6
    v_mul_f32 v6, s40, v6
    v_cos_f32 v149, v6
    v_sin_f32 v165, v6
    v_add_u32 v6, 26, v5
    v_mul_u32_u24 v6, v6, v4
    v_cvt_f32_u32 v6, v6
    v_mul_f32 v6, s40, v6
    v_cos_f32 v150, v6
    v_sin_f32 v166, v6
    v_add_u32 v6, 27, v5
    v_mul_u32_u24 v6, v6, v4
    v_cvt_f32_u32 v6, v6
    v_mul_f32 v6, s40, v6
    v_cos_f32 v151, v6
    v_sin_f32 v167, v6
    s_mov_b32 s60, 1060439283
    s_mov_b32 s61, 1060439283
    s_mov_b32 s29, 0
P1_round:
    s_waitcnt vmcnt(0)
    v_mov_b32 v96, 0
    v_mov_b32 v97, 0
    v_mov_b32 v98, 0
    v_mov_b32 v99, 0
    v_mov_b32 v100, 0
    v_mov_b32 v101, 0
    v_mov_b32 v102, 0
    v_mov_b32 v103, 0
    v_dot2_f32_bf16 v96, v32, v26, v96
    v_dot2_f32_bf16 v96, v33, v27, v96
    v_dot2_f32_bf16 v96, v34, v28, v96
    v_dot2_f32_bf16 v96, v35, v29, v96
    v_dot2_f32_bf16 v97, v36, v26, v97
    v_dot2_f32_bf16 v97, v37, v27, v97
    v_dot2_f32_bf16 v97, v38, v28, v97
    v_dot2_f32_bf16 v97, v39, v29, v97
    v_dot2_f32_bf16 v98, v40, v26, v98
    v_dot2_f32_bf16 v98, v41, v27, v98
    v_dot2_f32_bf16 v98, v42, v28, v98
    v_dot2_f32_bf16 v98, v43, v29, v98
    v_dot2_f32_bf16 v99, v44, v26, v99
    v_dot2_f32_bf16 v99, v45, v27, v99
    v_dot2_f32_bf16 v99, v46, v28, v99
    v_dot2_f32_bf16 v99, v47, v29, v99
    v_dot2_f32_bf16 v100, v48, v26, v100
    v_dot2_f32_bf16 v100, v49, v27, v100
    v_dot2_f32_bf16 v100, v50, v28, v100
    v_dot2_f32_bf16 v100, v51, v29, v100
    v_dot2_f32_bf16 v101, v52, v26, v101
    v_dot2_f32_bf16 v101, v53, v27, v101
    v_dot2_f32_bf16 v101, v54, v28, v101
    v_dot2_f32_bf16 v101, v55, v29, v101
    v_dot2_f32_bf16 v102, v56, v26, v102
    v_dot2_f32_bf16 v102, v57, v27, v102
    v_dot2_f32_bf16 v102, v58, v28, v102
    v_dot2_f32_bf16 v102, v59, v29, v102
    v_dot2_f32_bf16 v103, v60, v26, v103
    v_dot2_f32_bf16 v103, v61, v27, v103
    v_dot2_f32_bf16 v103, v62, v28, v103
    v_dot2_f32_bf16 v103, v63, v29, v103
    v_lshlrev_b32 v64, 16, v32
    v_and_b32 v65, 0xffff0000, v32
    v_lshlrev_b32 v66, 16, v36
    v_and_b32 v67, 0xffff0000, v36
    v_lshlrev_b32 v68, 16, v40
    v_and_b32 v69, 0xffff0000, v40
    v_lshlrev_b32 v70, 16, v44
    v_and_b32 v71, 0xffff0000, v44
    v_lshlrev_b32 v72, 16, v48
    v_and_b32 v73, 0xffff0000, v48
    v_lshlrev_b32 v74, 16, v52
    v_and_b32 v75, 0xffff0000, v52
    v_lshlrev_b32 v76, 16, v56
    v_and_b32 v77, 0xffff0000, v56
    v_lshlrev_b32 v78, 16, v60
    v_and_b32 v79, 0xffff0000, v60
    v_pk_add_f32 v[80:81], v[64:65], v[72:73]
    v_pk_add_f32 v[64:65], v[64:65], v[72:73] neg_lo:[0,1] neg_hi:[0,1]
    v_pk_add_f32 v[82:83], v[66:67], v[74:75]
    v_pk_add_f32 v[66:67], v[66:67], v[74:75] neg_lo:[0,1] neg_hi:[0,1]
    v_pk_add_f32 v[84:85], v[68:69], v[76:77]
    v_pk_add_f32 v[68:69], v[68:69], v[76:77] neg_lo:[0,1] neg_hi:[0,1]
    v_pk_add_f32 v[86:87], v[70:71], v[78:79]
    v_pk_add_f32 v[70:71], v[70:71], v[78:79] neg_lo:[0,1] neg_hi:[0,1]
    v_pk_add_f32 v[72:73], v[80:81], v[84:85]
    v_pk_add_f32 v[74:75], v[82:83], v[86:87]
    v_pk_add_f32 v[76:77], v[80:81], v[84:85] neg_lo:[0,1] neg_hi:[0,1]
    v_pk_add_f32 v[78:79], v[82:83], v[86:87] neg_lo:[0,1] neg_hi:[0,1]
    v_pk_add_f32 v[80:81], v[72:73], v[74:75]
    v_pk_add_f32 v[82:83], v[72:73], v[74:75] neg_lo:[0,1] neg_hi:[0,1]
    v_pk_add_f32 v[84:85], v[66:67], v[70:71] neg_lo:[0,1] neg_hi:[0,1]
    v_pk_add_f32 v[86:87], v[66:67], v[70:71]
    v_pk_fma_f32 v[88:89], v[84:85], s[60:61], v[64:65]
    v_pk_fma_f32 v[90:91], v[84:85], s[60:61], v[64:65] neg_lo:[1,0,0] neg_hi:[1,0,0]
    v_pk_fma_f32 v[92:93], v[86:87], s[60:61], v[68:69] neg_lo:[1,0,1] neg_hi:[1,0,1]
    v_pk_fma_f32 v[94:95], v[86:87], s[60:61], v[68:69] neg_lo:[1,0,0] neg_hi:[1,0,0]
    v_cvt_pk_bf16_f32 v64, v80, v82
    v_cvt_pk_bf16_f32 v65, v88, v92
    v_cvt_pk_bf16_f32 v66, v76, -v78
    v_cvt_pk_bf16_f32 v67, v90, v94
    ds_write_b32 v13, v64 offset:0
    ds_write_b32 v13, v65 offset:4096
    ds_write_b32 v13, v66 offset:8192
    ds_write_b32 v13, v67 offset:12288
    v_cvt_pk_bf16_f32 v68, v81, v83
    v_cvt_pk_bf16_f32 v69, v89, v93
    v_cvt_pk_bf16_f32 v70, v77, -v79
    v_cvt_pk_bf16_f32 v71, v91, v95
    ds_write_b32 v13, v68 offset:128
    ds_write_b32 v13, v69 offset:4224
    ds_write_b32 v13, v70 offset:8320
    ds_write_b32 v13, v71 offset:12416
    v_lshlrev_b32 v64, 16, v33
    v_and_b32 v65, 0xffff0000, v33
    v_lshlrev_b32 v66, 16, v37
    v_and_b32 v67, 0xffff0000, v37
    v_lshlrev_b32 v68, 16, v41
    v_and_b32 v69, 0xffff0000, v41
    v_lshlrev_b32 v70, 16, v45
    v_and_b32 v71, 0xffff0000, v45
    v_lshlrev_b32 v72, 16, v49
    v_and_b32 v73, 0xffff0000, v49
    v_lshlrev_b32 v74, 16, v53
    v_and_b32 v75, 0xffff0000, v53
    v_lshlrev_b32 v76, 16, v57
    v_and_b32 v77, 0xffff0000, v57
    v_lshlrev_b32 v78, 16, v61
    v_and_b32 v79, 0xffff0000, v61
    v_pk_add_f32 v[80:81], v[64:65], v[72:73]
    v_pk_add_f32 v[64:65], v[64:65], v[72:73] neg_lo:[0,1] neg_hi:[0,1]
    v_pk_add_f32 v[82:83], v[66:67], v[74:75]
    v_pk_add_f32 v[66:67], v[66:67], v[74:75] neg_lo:[0,1] neg_hi:[0,1]
    v_pk_add_f32 v[84:85], v[68:69], v[76:77]
    v_pk_add_f32 v[68:69], v[68:69], v[76:77] neg_lo:[0,1] neg_hi:[0,1]
    v_pk_add_f32 v[86:87], v[70:71], v[78:79]
    v_pk_add_f32 v[70:71], v[70:71], v[78:79] neg_lo:[0,1] neg_hi:[0,1]
    v_pk_add_f32 v[72:73], v[80:81], v[84:85]
    v_pk_add_f32 v[74:75], v[82:83], v[86:87]
    v_pk_add_f32 v[76:77], v[80:81], v[84:85] neg_lo:[0,1] neg_hi:[0,1]
    v_pk_add_f32 v[78:79], v[82:83], v[86:87] neg_lo:[0,1] neg_hi:[0,1]
    v_pk_add_f32 v[80:81], v[72:73], v[74:75]
    v_pk_add_f32 v[82:83], v[72:73], v[74:75] neg_lo:[0,1] neg_hi:[0,1]
    v_pk_add_f32 v[84:85], v[66:67], v[70:71] neg_lo:[0,1] neg_hi:[0,1]
    v_pk_add_f32 v[86:87], v[66:67], v[70:71]
    v_pk_fma_f32 v[88:89], v[84:85], s[60:61], v[64:65]
    v_pk_fma_f32 v[90:91], v[84:85], s[60:61], v[64:65] neg_lo:[1,0,0] neg_hi:[1,0,0]
    v_pk_fma_f32 v[92:93], v[86:87], s[60:61], v[68:69] neg_lo:[1,0,1] neg_hi:[1,0,1]
    v_pk_fma_f32 v[94:95], v[86:87], s[60:61], v[68:69] neg_lo:[1,0,0] neg_hi:[1,0,0]
    v_cvt_pk_bf16_f32 v64, v80, v82
    v_cvt_pk_bf16_f32 v65, v88, v92
    v_cvt_pk_bf16_f32 v66, v76, -v78
    v_cvt_pk_bf16_f32 v67, v90, v94
    ds_write_b32 v14, v64 offset:0
    ds_write_b32 v14, v65 offset:4096
    ds_write_b32 v14, v66 offset:8192
    ds_write_b32 v14, v67 offset:12288
    v_cvt_pk_bf16_f32 v68, v81, v83
    v_cvt_pk_bf16_f32 v69, v89, v93
    v_cvt_pk_bf16_f32 v70, v77, -v79
    v_cvt_pk_bf16_f32 v71, v91, v95
    ds_write_b32 v14, v68 offset:128
    ds_write_b32 v14, v69 offset:4224
    ds_write_b32 v14, v70 offset:8320
    ds_write_b32 v14, v71 offset:12416
    v_lshlrev_b32 v64, 16, v34
    v_and_b32 v65, 0xffff0000, v34
    v_lshlrev_b32 v66, 16, v38
    v_and_b32 v67, 0xffff0000, v38
    v_lshlrev_b32 v68, 16, v42
    v_and_b32 v69, 0xffff0000, v42
    v_lshlrev_b32 v70, 16, v46
    v_and_b32 v71, 0xffff0000, v46
    v_lshlrev_b32 v72, 16, v50
    v_and_b32 v73, 0xffff0000, v50
    v_lshlrev_b32 v74, 16, v54
    v_and_b32 v75, 0xffff0000, v54
    v_lshlrev_b32 v76, 16, v58
    v_and_b32 v77, 0xffff0000, v58
    v_lshlrev_b32 v78, 16, v62
    v_and_b32 v79, 0xffff0000, v62
    v_pk_add_f32 v[80:81], v[64:65], v[72:73]
    v_pk_add_f32 v[64:65], v[64:65], v[72:73] neg_lo:[0,1] neg_hi:[0,1]
    v_pk_add_f32 v[82:83], v[66:67], v[74:75]
    v_pk_add_f32 v[66:67], v[66:67], v[74:75] neg_lo:[0,1] neg_hi:[0,1]
    v_pk_add_f32 v[84:85], v[68:69], v[76:77]
    v_pk_add_f32 v[68:69], v[68:69], v[76:77] neg_lo:[0,1] neg_hi:[0,1]
    v_pk_add_f32 v[86:87], v[70:71], v[78:79]
    v_pk_add_f32 v[70:71], v[70:71], v[78:79] neg_lo:[0,1] neg_hi:[0,1]
    v_pk_add_f32 v[72:73], v[80:81], v[84:85]
    v_pk_add_f32 v[74:75], v[82:83], v[86:87]
    v_pk_add_f32 v[76:77], v[80:81], v[84:85] neg_lo:[0,1] neg_hi:[0,1]
    v_pk_add_f32 v[78:79], v[82:83], v[86:87] neg_lo:[0,1] neg_hi:[0,1]
    v_pk_add_f32 v[80:81], v[72:73], v[74:75]
    v_pk_add_f32 v[82:83], v[72:73], v[74:75] neg_lo:[0,1] neg_hi:[0,1]
    v_pk_add_f32 v[84:85], v[66:67], v[70:71] neg_lo:[0,1] neg_hi:[0,1]
    v_pk_add_f32 v[86:87], v[66:67], v[70:71]
    v_pk_fma_f32 v[88:89], v[84:85], s[60:61], v[64:65]
    v_pk_fma_f32 v[90:91], v[84:85], s[60:61], v[64:65] neg_lo:[1,0,0] neg_hi:[1,0,0]
    v_pk_fma_f32 v[92:93], v[86:87], s[60:61], v[68:69] neg_lo:[1,0,1] neg_hi:[1,0,1]
    v_pk_fma_f32 v[94:95], v[86:87], s[60:61], v[68:69] neg_lo:[1,0,0] neg_hi:[1,0,0]
    v_cvt_pk_bf16_f32 v64, v80, v82
    v_cvt_pk_bf16_f32 v65, v88, v92
    v_cvt_pk_bf16_f32 v66, v76, -v78
    v_cvt_pk_bf16_f32 v67, v90, v94
    ds_write_b32 v15, v64 offset:0
    ds_write_b32 v15, v65 offset:4096
    ds_write_b32 v15, v66 offset:8192
    ds_write_b32 v15, v67 offset:12288
    v_cvt_pk_bf16_f32 v68, v81, v83
    v_cvt_pk_bf16_f32 v69, v89, v93
    v_cvt_pk_bf16_f32 v70, v77, -v79
    v_cvt_pk_bf16_f32 v71, v91, v95
    ds_write_b32 v15, v68 offset:128
    ds_write_b32 v15, v69 offset:4224
    ds_write_b32 v15, v70 offset:8320
    ds_write_b32 v15, v71 offset:12416
    v_lshlrev_b32 v64, 16, v35
    v_and_b32 v65, 0xffff0000, v35
    v_lshlrev_b32 v66, 16, v39
    v_and_b32 v67, 0xffff0000, v39
    v_lshlrev_b32 v68, 16, v43
    v_and_b32 v69, 0xffff0000, v43
    v_lshlrev_b32 v70, 16, v47
    v_and_b32 v71, 0xffff0000, v47
    v_lshlrev_b32 v72, 16, v51
    v_and_b32 v73, 0xffff0000, v51
    v_lshlrev_b32 v74, 16, v55
    v_and_b32 v75, 0xffff0000, v55
    v_lshlrev_b32 v76, 16, v59
    v_and_b32 v77, 0xffff0000, v59
    v_lshlrev_b32 v78, 16, v63
    v_and_b32 v79, 0xffff0000, v63
    v_pk_add_f32 v[80:81], v[64:65], v[72:73]
    v_pk_add_f32 v[64:65], v[64:65], v[72:73] neg_lo:[0,1] neg_hi:[0,1]
    v_pk_add_f32 v[82:83], v[66:67], v[74:75]
    v_pk_add_f32 v[66:67], v[66:67], v[74:75] neg_lo:[0,1] neg_hi:[0,1]
    v_pk_add_f32 v[84:85], v[68:69], v[76:77]
    v_pk_add_f32 v[68:69], v[68:69], v[76:77] neg_lo:[0,1] neg_hi:[0,1]
    v_pk_add_f32 v[86:87], v[70:71], v[78:79]
    v_pk_add_f32 v[70:71], v[70:71], v[78:79] neg_lo:[0,1] neg_hi:[0,1]
    v_pk_add_f32 v[72:73], v[80:81], v[84:85]
    v_pk_add_f32 v[74:75], v[82:83], v[86:87]
    v_pk_add_f32 v[76:77], v[80:81], v[84:85] neg_lo:[0,1] neg_hi:[0,1]
    v_pk_add_f32 v[78:79], v[82:83], v[86:87] neg_lo:[0,1] neg_hi:[0,1]
    v_pk_add_f32 v[80:81], v[72:73], v[74:75]
    v_pk_add_f32 v[82:83], v[72:73], v[74:75] neg_lo:[0,1] neg_hi:[0,1]
    v_pk_add_f32 v[84:85], v[66:67], v[70:71] neg_lo:[0,1] neg_hi:[0,1]
    v_pk_add_f32 v[86:87], v[66:67], v[70:71]
    v_pk_fma_f32 v[88:89], v[84:85], s[60:61], v[64:65]
    v_pk_fma_f32 v[90:91], v[84:85], s[60:61], v[64:65] neg_lo:[1,0,0] neg_hi:[1,0,0]
    v_pk_fma_f32 v[92:93], v[86:87], s[60:61], v[68:69] neg_lo:[1,0,1] neg_hi:[1,0,1]
    v_pk_fma_f32 v[94:95], v[86:87], s[60:61], v[68:69] neg_lo:[1,0,0] neg_hi:[1,0,0]
    v_cvt_pk_bf16_f32 v64, v80, v82
    v_cvt_pk_bf16_f32 v65, v88, v92
    v_cvt_pk_bf16_f32 v66, v76, -v78
    v_cvt_pk_bf16_f32 v67, v90, v94
    ds_write_b32 v16, v64 offset:0
    ds_write_b32 v16, v65 offset:4096
    ds_write_b32 v16, v66 offset:8192
    ds_write_b32 v16, v67 offset:12288
    v_cvt_pk_bf16_f32 v68, v81, v83
    v_cvt_pk_bf16_f32 v69, v89, v93
    v_cvt_pk_bf16_f32 v70, v77, -v79
    v_cvt_pk_bf16_f32 v71, v91, v95
    ds_write_b32 v16, v68 offset:128
    ds_write_b32 v16, v69 offset:4224
    ds_write_b32 v16, v70 offset:8320
    ds_write_b32 v16, v71 offset:12416
    v_add_f32_dpp v96, v96, v96 row_ror:8 row_mask:0xf bank_mask:0xf
    v_add_f32_dpp v97, v97, v97 row_ror:8 row_mask:0xf bank_mask:0xf
    v_add_f32_dpp v98, v98, v98 row_ror:8 row_mask:0xf bank_mask:0xf
    v_add_f32_dpp v99, v99, v99 row_ror:8 row_mask:0xf bank_mask:0xf
    v_add_f32_dpp v100, v100, v100 row_ror:8 row_mask:0xf bank_mask:0xf
    v_add_f32_dpp v101, v101, v101 row_ror:8 row_mask:0xf bank_mask:0xf
    v_add_f32_dpp v102, v102, v102 row_ror:8 row_mask:0xf bank_mask:0xf
    v_add_f32_dpp v103, v103, v103 row_ror:8 row_mask:0xf bank_mask:0xf
    v_add_f32_dpp v96, v96, v96 row_ror:4 row_mask:0xf bank_mask:0xf
    v_add_f32_dpp v97, v97, v97 row_ror:4 row_mask:0xf bank_mask:0xf
    v_add_f32_dpp v98, v98, v98 row_ror:4 row_mask:0xf bank_mask:0xf
    v_add_f32_dpp v99, v99, v99 row_ror:4 row_mask:0xf bank_mask:0xf
    v_add_f32_dpp v100, v100, v100 row_ror:4 row_mask:0xf bank_mask:0xf
    v_add_f32_dpp v101, v101, v101 row_ror:4 row_mask:0xf bank_mask:0xf
    v_add_f32_dpp v102, v102, v102 row_ror:4 row_mask:0xf bank_mask:0xf
    v_add_f32_dpp v103, v103, v103 row_ror:4 row_mask:0xf bank_mask:0xf
    v_add_f32_dpp v96, v96, v96 row_ror:2 row_mask:0xf bank_mask:0xf
    v_add_f32_dpp v97, v97, v97 row_ror:2 row_mask:0xf bank_mask:0xf
    v_add_f32_dpp v98, v98, v98 row_ror:2 row_mask:0xf bank_mask:0xf
    v_add_f32_dpp v99, v99, v99 row_ror:2 row_mask:0xf bank_mask:0xf
    v_add_f32_dpp v100, v100, v100 row_ror:2 row_mask:0xf bank_mask:0xf
    v_add_f32_dpp v101, v101, v101 row_ror:2 row_mask:0xf bank_mask:0xf
    v_add_f32_dpp v102, v102, v102 row_ror:2 row_mask:0xf bank_mask:0xf
    v_add_f32_dpp v103, v103, v103 row_ror:2 row_mask:0xf bank_mask:0xf
    v_add_f32_dpp v96, v96, v96 row_ror:1 row_mask:0xf bank_mask:0xf
    v_add_f32_dpp v97, v97, v97 row_ror:1 row_mask:0xf bank_mask:0xf
    v_add_f32_dpp v98, v98, v98 row_ror:1 row_mask:0xf bank_mask:0xf
    v_add_f32_dpp v99, v99, v99 row_ror:1 row_mask:0xf bank_mask:0xf
    v_add_f32_dpp v100, v100, v100 row_ror:1 row_mask:0xf bank_mask:0xf
    v_add_f32_dpp v101, v101, v101 row_ror:1 row_mask:0xf bank_mask:0xf
    v_add_f32_dpp v102, v102, v102 row_ror:1 row_mask:0xf bank_mask:0xf
    v_add_f32_dpp v103, v103, v103 row_ror:1 row_mask:0xf bank_mask:0xf
    s_mov_b64 s[42:43], exec
    s_mov_b32 exec_lo, 0x00010001
    s_mov_b32 exec_hi, 0x00010001
    ds_write_b32 v25, v96 offset:0
    ds_write_b32 v25, v97 offset:32
    ds_write_b32 v25, v98 offset:64
    ds_write_b32 v25, v99 offset:96
    ds_write_b32 v25, v100 offset:128
    ds_write_b32 v25, v101 offset:160
    ds_write_b32 v25, v102 offset:192
    ds_write_b32 v25, v103 offset:224
    s_mov_b64 exec, s[42:43]
    s_cmp_eq_u32 s29, 0
    s_cbranch_scc0 P1_nopf
    v_add_u32 v12, 8192, v12
    buffer_load_dwordx4 v[32:35], v12, s[12:15], s50 offen
    buffer_load_dwordx4 v[36:39], v12, s[12:15], s51 offen
    buffer_load_dwordx4 v[40:43], v12, s[12:15], s52 offen
    buffer_load_dwordx4 v[44:47], v12, s[12:15], s53 offen
    buffer_load_dwordx4 v[48:51], v12, s[12:15], s54 offen
    buffer_load_dwordx4 v[52:55], v12, s[12:15], s55 offen
    buffer_load_dwordx4 v[56:59], v12, s[12:15], s56 offen
    buffer_load_dwordx4 v[60:63], v12, s[12:15], s57 offen
    s_branch P1_pfdone
P1_nopf:
    s_waitcnt lgkmcnt(0)
    s_mov_b32 s12, s4
    s_mov_b32 s13, s5
    s_mov_b32 s14, 2101248
    s_mov_b32 s15, 0x20000
    s_mov_b32 s16, s6
    s_mov_b32 s17, s7
    s_mov_b32 s18, 2101248
    s_mov_b32 s19, 0x20000
    s_lshl_b32 s62, s22, 3
    s_add_u32 s62, s62, s31
    s_mul_i32 s63, s62, 1026
    v_lshlrev_b32 v30, 4, v2
    s_and_b32 s58, s31, 3
P1_pfdone:
    s_waitcnt lgkmcnt(0)
    s_barrier
    s_cmp_eq_u32 s31, 0
    s_cbranch_scc0 P1_nogate
    v_lshlrev_b32 v4, 5, v2
    v_add_u32 v4, 133120, v4
    ds_read_b128 v[200:203], v4
    ds_read_b128 v[204:207], v4 offset:16
    s_waitcnt lgkmcnt(0)
    v_add_f32 v200, v200, v201
    v_add_f32 v202, v202, v203
    v_add_f32 v204, v204, v205
    v_add_f32 v206, v206, v207
    v_add_f32 v200, v200, v202
    v_add_f32 v204, v204, v206
    v_add_f32 v200, v200, v204
    v_cvt_pk_bf16_f32 v200, v200, v200
    v_lshlrev_b32 v200, 16, v200
    v_mul_f32 v200, 3216550459, v200
    v_exp_f32 v200, v200
    s_nop 0
    v_add_f32 v200, 1.0, v200
    v_rcp_f32 v200, v200
    s_nop 0
    v_cvt_pk_bf16_f32 v200, v200, v200
    v_lshlrev_b32 v200, 16, v200
    v_and_b32 v4, 7, v2
    v_lshlrev_b32 v4, 8, v4
    v_lshrrev_b32 v5, 3, v2
    v_add_u32 v4, v4, v5
    s_lshl_b32 s40, s29, 2
    s_add_u32 s40, s40, s22
    v_add_u32 v4, s40, v4
    v_lshlrev_b32 v4, 2, v4
    s_mov_b64 s[42:43], exec
    s_mov_b32 exec_lo, -1
    s_mov_b32 exec_hi, 0
    buffer_store_dword v200, v4, s[32:35], 0 offen sc1
    s_mov_b64 exec, s[42:43]
P1_nogate:
    ds_read_b128 v[200:203], v17 offset:0
    ds_read_b128 v[204:207], v18 offset:0
    ds_read_b128 v[208:211], v19 offset:0
    ds_read_b128 v[212:215], v20 offset:0
    s_waitcnt lgkmcnt(0)
    v_mfma_f32_32x32x16_bf16 v[168:183], v[200:203], v[104:107], 0
    v_mfma_f32_32x32x16_bf16 v[184:199], v[200:203], v[120:123], 0
    v_mfma_f32_32x32x16_bf16 v[168:183], v[204:207], v[108:111], v[168:183]
    v_mfma_f32_32x32x16_bf16 v[184:199], v[204:207], v[124:127], v[184:199]
    v_mfma_f32_32x32x16_bf16 v[168:183], v[208:211], v[112:115], v[168:183]
    v_mfma_f32_32x32x16_bf16 v[184:199], v[208:211], v[128:131], v[184:199]
    v_mfma_f32_32x32x16_bf16 v[168:183], v[212:215], v[116:119], v[168:183]
    v_mfma_f32_32x32x16_bf16 v[184:199], v[212:215], v[132:135], v[184:199]
    s_cmp_eq_u32 s29, 1
    s_cbranch_scc0 P1wg_52
    s_cmp_eq_u32 s58, 0
    s_cbranch_scc0 W0_53
    s_add_u32 s40, s63, 0
    buffer_load_dwordx4 v[32:35], v30, s[12:15], s40 offen nt
    buffer_load_dwordx4 v[64:67], v30, s[16:19], s40 offen nt
    s_add_u32 s40, s63, 8208
    buffer_load_dwordx4 v[36:39], v30, s[12:15], s40 offen nt
    buffer_load_dwordx4 v[68:71], v30, s[16:19], s40 offen nt
W0_53:
P1wg_52:
    s_nop 7
    s_nop 3
    v_pk_mul_f32 v[4:5], v[168:169], v[136:137]
    v_pk_mul_f32 v[6:7], v[184:185], v[136:137]
    v_pk_fma_f32 v[4:5], v[184:185], v[152:153], v[4:5]
    v_pk_fma_f32 v[6:7], v[168:169], v[152:153], v[6:7] neg_lo:[1,0,0] neg_hi:[1,0,0]
    v_cvt_pk_bf16_f32 v200, v4, v6
    v_cvt_pk_bf16_f32 v201, v5, v7
    v_pk_mul_f32 v[8:9], v[170:171], v[138:139]
    v_pk_mul_f32 v[10:11], v[186:187], v[138:139]
    v_pk_fma_f32 v[8:9], v[186:187], v[154:155], v[8:9]
    v_pk_fma_f32 v[10:11], v[170:171], v[154:155], v[10:11] neg_lo:[1,0,0] neg_hi:[1,0,0]
    v_cvt_pk_bf16_f32 v202, v8, v10
    v_cvt_pk_bf16_f32 v203, v9, v11
    v_pk_mul_f32 v[4:5], v[172:173], v[140:141]
    v_pk_mul_f32 v[6:7], v[188:189], v[140:141]
    v_pk_fma_f32 v[4:5], v[188:189], v[156:157], v[4:5]
    v_pk_fma_f32 v[6:7], v[172:173], v[156:157], v[6:7] neg_lo:[1,0,0] neg_hi:[1,0,0]
    v_cvt_pk_bf16_f32 v204, v4, v6
    v_cvt_pk_bf16_f32 v205, v5, v7
    v_pk_mul_f32 v[8:9], v[174:175], v[142:143]
    v_pk_mul_f32 v[10:11], v[190:191], v[142:143]
    v_pk_fma_f32 v[8:9], v[190:191], v[158:159], v[8:9]
    v_pk_fma_f32 v[10:11], v[174:175], v[158:159], v[10:11] neg_lo:[1,0,0] neg_hi:[1,0,0]
    v_cvt_pk_bf16_f32 v206, v8, v10
    v_cvt_pk_bf16_f32 v207, v9, v11
    v_pk_mul_f32 v[4:5], v[176:177], v[144:145]
    v_pk_mul_f32 v[6:7], v[192:193], v[144:145]
    v_pk_fma_f32 v[4:5], v[192:193], v[160:161], v[4:5]
    v_pk_fma_f32 v[6:7], v[176:177], v[160:161], v[6:7] neg_lo:[1,0,0] neg_hi:[1,0,0]
    v_cvt_pk_bf16_f32 v208, v4, v6
    v_cvt_pk_bf16_f32 v209, v5, v7
    v_pk_mul_f32 v[8:9], v[178:179], v[146:147]
    v_pk_mul_f32 v[10:11], v[194:195], v[146:147]
    v_pk_fma_f32 v[8:9], v[194:195], v[162:163], v[8:9]
    v_pk_fma_f32 v[10:11], v[178:179], v[162:163], v[10:11] neg_lo:[1,0,0] neg_hi:[1,0,0]
    v_cvt_pk_bf16_f32 v210, v8, v10
    v_cvt_pk_bf16_f32 v211, v9, v11
    v_pk_mul_f32 v[4:5], v[180:181], v[148:149]
    v_pk_mul_f32 v[6:7], v[196:197], v[148:149]
    v_pk_fma_f32 v[4:5], v[196:197], v[164:165], v[4:5]
    v_pk_fma_f32 v[6:7], v[180:181], v[164:165], v[6:7] neg_lo:[1,0,0] neg_hi:[1,0,0]
    v_cvt_pk_bf16_f32 v212, v4, v6
    v_cvt_pk_bf16_f32 v213, v5, v7
    v_pk_mul_f32 v[8:9], v[182:183], v[150:151]
    v_pk_mul_f32 v[10:11], v[198:199], v[150:151]
    v_pk_fma_f32 v[8:9], v[198:199], v[166:167], v[8:9]
    v_pk_fma_f32 v[10:11], v[182:183], v[166:167], v[10:11] neg_lo:[1,0,0] neg_hi:[1,0,0]
    v_cvt_pk_bf16_f32 v214, v8, v10
    v_cvt_pk_bf16_f32 v215, v9, v11
    s_nop 1
    v_mfma_f32_32x32x16_bf16 v[168:183], v[104:107], v[200:203], 0
    v_mfma_f32_32x32x16_bf16 v[184:199], v[120:123], v[200:203], 0
    v_mfma_f32_32x32x16_bf16 v[168:183], v[108:111], v[204:207], v[168:183]
    v_mfma_f32_32x32x16_bf16 v[184:199], v[124:127], v[204:207], v[184:199]
    v_mfma_f32_32x32x16_bf16 v[168:183], v[112:115], v[208:211], v[168:183]
    v_mfma_f32_32x32x16_bf16 v[184:199], v[128:131], v[208:211], v[184:199]
    v_mfma_f32_32x32x16_bf16 v[168:183], v[116:119], v[212:215], v[168:183]
    v_mfma_f32_32x32x16_bf16 v[184:199], v[132:135], v[212:215], v[184:199]
    s_cmp_eq_u32 s29, 1
    s_cbranch_scc0 P1wg_54
    s_cmp_eq_u32 s58, 0
    s_cbranch_scc0 W0_55
    s_add_u32 s40, s63, 16416
    buffer_load_dwordx4 v[40:43], v30, s[12:15], s40 offen nt
    buffer_load_dwordx4 v[72:75], v30, s[16:19], s40 offen nt
    s_add_u32 s40, s63, 24624
    buffer_load_dwordx4 v[44:47], v30, s[12:15], s40 offen nt
    buffer_load_dwordx4 v[76:79], v30, s[16:19], s40 offen nt
W0_55:
P1wg_54:
    s_nop 7
    s_nop 3
    v_cvt_pk_bf16_f32 v200, v168, v184
    v_cvt_pk_bf16_f32 v201, v169, v185
    v_cvt_pk_bf16_f32 v202, v170, v186
    v_cvt_pk_bf16_f32 v203, v171, v187
    v_cvt_pk_bf16_f32 v204, v172, v188
    v_cvt_pk_bf16_f32 v205, v173, v189
    v_cvt_pk_bf16_f32 v206, v174, v190
    v_cvt_pk_bf16_f32 v207, v175, v191
    v_cvt_pk_bf16_f32 v208, v176, v192
    v_cvt_pk_bf16_f32 v209, v177, v193
    v_cvt_pk_bf16_f32 v210, v178, v194
    v_cvt_pk_bf16_f32 v211, v179, v195
    v_cvt_pk_bf16_f32 v212, v180, v196
    v_cvt_pk_bf16_f32 v213, v181, v197
    v_cvt_pk_bf16_f32 v214, v182, v198
    v_cvt_pk_bf16_f32 v215, v183, v199
    s_cmp_eq_u32 s23, 0
    s_cbranch_scc1 P1w0_56
    ds_write_b32 v21, v200 offset:0
    ds_write_b32 v21, v201 offset:256
    ds_write_b32 v21, v202 offset:512
    ds_write_b32 v21, v203 offset:768
    ds_write_b32 v21, v204 offset:2048
    ds_write_b32 v21, v205 offset:2304
    ds_write_b32 v21, v206 offset:2560
    ds_write_b32 v21, v207 offset:2816
    ds_write_b32 v21, v208 offset:4096
    ds_write_b32 v21, v209 offset:4352
    ds_write_b32 v21, v210 offset:4608
    ds_write_b32 v21, v211 offset:4864
    ds_write_b32 v21, v212 offset:6144
    ds_write_b32 v21, v213 offset:6400
    ds_write_b32 v21, v214 offset:6656
    ds_write_b32 v21, v215 offset:6912
    s_branch P1w1_57
P1w0_56:
    ds_write_b32 v21, v200 offset:0
    ds_write_b32 v21, v201 offset:512
    ds_write_b32 v21, v202 offset:1024
    ds_write_b32 v21, v203 offset:1536
    ds_write_b32 v21, v204 offset:4096
    ds_write_b32 v21, v205 offset:4608
    ds_write_b32 v21, v206 offset:5120
    ds_write_b32 v21, v207 offset:5632
    ds_write_b32 v22, v208 offset:5632
    ds_write_b32 v22, v209 offset:5120
    ds_write_b32 v22, v210 offset:4608
    ds_write_b32 v22, v211 offset:4096
    ds_write_b32 v22, v212 offset:1536
    ds_write_b32 v22, v213 offset:1024
    ds_write_b32 v22, v214 offset:512
    ds_write_b32 v22, v215 offset:0
    s_mov_b64 s[42:43], exec
    s_mov_b64 exec, 1
    v_mov_b32 v4, s27
    ds_write_b32 v4, v200 offset:32
    ds_write_b32 v4, v208 offset:8192
    s_mov_b64 exec, s[42:43]
P1w1_57:
    ds_read_b128 v[200:203], v17 offset:16384
    ds_read_b128 v[204:207], v18 offset:16384
    ds_read_b128 v[208:211], v19 offset:16384
    ds_read_b128 v[212:215], v20 offset:16384
    s_waitcnt lgkmcnt(0)
    v_mfma_f32_32x32x16_bf16 v[168:183], v[200:203], v[104:107], 0
    v_mfma_f32_32x32x16_bf16 v[184:199], v[200:203], v[120:123], 0
    v_mfma_f32_32x32x16_bf16 v[168:183], v[204:207], v[108:111], v[168:183]
    v_mfma_f32_32x32x16_bf16 v[184:199], v[204:207], v[124:127], v[184:199]
    v_mfma_f32_32x32x16_bf16 v[168:183], v[208:211], v[112:115], v[168:183]
    v_mfma_f32_32x32x16_bf16 v[184:199], v[208:211], v[128:131], v[184:199]
    v_mfma_f32_32x32x16_bf16 v[168:183], v[212:215], v[116:119], v[168:183]
    v_mfma_f32_32x32x16_bf16 v[184:199], v[212:215], v[132:135], v[184:199]
    s_cmp_eq_u32 s29, 1
    s_cbranch_scc0 P1wg_58
    s_cmp_eq_u32 s58, 0
    s_cbranch_scc0 W0_59
    s_add_u32 s40, s63, 32832
    buffer_load_dwordx4 v[48:51], v30, s[12:15], s40 offen nt
    buffer_load_dwordx4 v[80:83], v30, s[16:19], s40 offen nt
    s_add_u32 s40, s63, 41040
    buffer_load_dwordx4 v[52:55], v30, s[12:15], s40 offen nt
    buffer_load_dwordx4 v[84:87], v30, s[16:19], s40 offen nt
W0_59:
P1wg_58:
    s_nop 7
    s_nop 3
    v_pk_mul_f32 v[4:5], v[168:169], v[136:137]
    v_pk_mul_f32 v[6:7], v[184:185], v[136:137]
    v_pk_fma_f32 v[4:5], v[184:185], v[152:153], v[4:5]
    v_pk_fma_f32 v[6:7], v[168:169], v[152:153], v[6:7] neg_lo:[1,0,0] neg_hi:[1,0,0]
    v_cvt_pk_bf16_f32 v200, v4, v6
    v_cvt_pk_bf16_f32 v201, v5, v7
    v_pk_mul_f32 v[8:9], v[170:171], v[138:139]
    v_pk_mul_f32 v[10:11], v[186:187], v[138:139]
    v_pk_fma_f32 v[8:9], v[186:187], v[154:155], v[8:9]
    v_pk_fma_f32 v[10:11], v[170:171], v[154:155], v[10:11] neg_lo:[1,0,0] neg_hi:[1,0,0]
    v_cvt_pk_bf16_f32 v202, v8, v10
    v_cvt_pk_bf16_f32 v203, v9, v11
    v_pk_mul_f32 v[4:5], v[172:173], v[140:141]
    v_pk_mul_f32 v[6:7], v[188:189], v[140:141]
    v_pk_fma_f32 v[4:5], v[188:189], v[156:157], v[4:5]
    v_pk_fma_f32 v[6:7], v[172:173], v[156:157], v[6:7] neg_lo:[1,0,0] neg_hi:[1,0,0]
    v_cvt_pk_bf16_f32 v204, v4, v6
    v_cvt_pk_bf16_f32 v205, v5, v7
    v_pk_mul_f32 v[8:9], v[174:175], v[142:143]
    v_pk_mul_f32 v[10:11], v[190:191], v[142:143]
    v_pk_fma_f32 v[8:9], v[190:191], v[158:159], v[8:9]
    v_pk_fma_f32 v[10:11], v[174:175], v[158:159], v[10:11] neg_lo:[1,0,0] neg_hi:[1,0,0]
    v_cvt_pk_bf16_f32 v206, v8, v10
    v_cvt_pk_bf16_f32 v207, v9, v11
    v_pk_mul_f32 v[4:5], v[176:177], v[144:145]
    v_pk_mul_f32 v[6:7], v[192:193], v[144:145]
    v_pk_fma_f32 v[4:5], v[192:193], v[160:161], v[4:5]
    v_pk_fma_f32 v[6:7], v[176:177], v[160:161], v[6:7] neg_lo:[1,0,0] neg_hi:[1,0,0]
    v_cvt_pk_bf16_f32 v208, v4, v6
    v_cvt_pk_bf16_f32 v209, v5, v7
    v_pk_mul_f32 v[8:9], v[178:179], v[146:147]
    v_pk_mul_f32 v[10:11], v[194:195], v[146:147]
    v_pk_fma_f32 v[8:9], v[194:195], v[162:163], v[8:9]
    v_pk_fma_f32 v[10:11], v[178:179], v[162:163], v[10:11] neg_lo:[1,0,0] neg_hi:[1,0,0]
    v_cvt_pk_bf16_f32 v210, v8, v10
    v_cvt_pk_bf16_f32 v211, v9, v11
    v_pk_mul_f32 v[4:5], v[180:181], v[148:149]
    v_pk_mul_f32 v[6:7], v[196:197], v[148:149]
    v_pk_fma_f32 v[4:5], v[196:197], v[164:165], v[4:5]
    v_pk_fma_f32 v[6:7], v[180:181], v[164:165], v[6:7] neg_lo:[1,0,0] neg_hi:[1,0,0]
    v_cvt_pk_bf16_f32 v212, v4, v6
    v_cvt_pk_bf16_f32 v213, v5, v7
    v_pk_mul_f32 v[8:9], v[182:183], v[150:151]
    v_pk_mul_f32 v[10:11], v[198:199], v[150:151]
    v_pk_fma_f32 v[8:9], v[198:199], v[166:167], v[8:9]
    v_pk_fma_f32 v[10:11], v[182:183], v[166:167], v[10:11] neg_lo:[1,0,0] neg_hi:[1,0,0]
    v_cvt_pk_bf16_f32 v214, v8, v10
    v_cvt_pk_bf16_f32 v215, v9, v11
    s_nop 1
    v_mfma_f32_32x32x16_bf16 v[168:183], v[104:107], v[200:203], 0
    v_mfma_f32_32x32x16_bf16 v[184:199], v[120:123], v[200:203], 0
    v_mfma_f32_32x32x16_bf16 v[168:183], v[108:111], v[204:207], v[168:183]
    v_mfma_f32_32x32x16_bf16 v[184:199], v[124:127], v[204:207], v[184:199]
    v_mfma_f32_32x32x16_bf16 v[168:183], v[112:115], v[208:211], v[168:183]
    v_mfma_f32_32x32x16_bf16 v[184:199], v[128:131], v[208:211], v[184:199]
    v_mfma_f32_32x32x16_bf16 v[168:183], v[116:119], v[212:215], v[168:183]
    v_mfma_f32_32x32x16_bf16 v[184:199], v[132:135], v[212:215], v[184:199]
    s_cmp_eq_u32 s29, 1
    s_cbranch_scc0 P1wg_60
    s_cmp_eq_u32 s58, 0
    s_cbranch_scc0 W0_61
    s_add_u32 s40, s63, 49248
    buffer_load_dwordx4 v[56:59], v30, s[12:15], s40 offen nt
    buffer_load_dwordx4 v[88:91], v30, s[16:19], s40 offen nt
    s_add_u32 s40, s63, 57456
    buffer_load_dwordx4 v[60:63], v30, s[12:15], s40 offen nt
    buffer_load_dwordx4 v[92:95], v30, s[16:19], s40 offen nt
W0_61:
    s_cmp_eq_u32 s58, 0
    s_cbranch_scc0 W0_62
    v_and_b32 v5, 7, v2
    v_lshlrev_b32 v5, 3, v5
    v_add_u32 v5, s62, v5
    v_sub_u32 v6, 2048, v5
    v_and_b32 v6, 2047, v6
    s_mov_b32 s40, 1026
    v_mul_lo_u32 v5, v5, s40
    v_mul_lo_u32 v6, v6, s40
    buffer_load_ushort v248, v5, s[12:15], 0 offen
    buffer_load_ushort v249, v5, s[16:19], 0 offen
    buffer_load_ushort v250, v5, s[12:15], 0 offen offset:1024
    buffer_load_ushort v251, v5, s[16:19], 0 offen offset:1024
    buffer_load_ushort v252, v6, s[12:15], 0 offen
    buffer_load_ushort v253, v6, s[16:19], 0 offen
    buffer_load_ushort v254, v6, s[12:15], 0 offen offset:1024
    buffer_load_ushort v255, v6, s[16:19], 0 offen offset:1024
W0_62:
P1wg_60:
    s_nop 7
    s_nop 3
    v_cvt_pk_bf16_f32 v200, v168, v184
    v_cvt_pk_bf16_f32 v201, v169, v185
    v_cvt_pk_bf16_f32 v202, v170, v186
    v_cvt_pk_bf16_f32 v203, v171, v187
    v_cvt_pk_bf16_f32 v204, v172, v188
    v_cvt_pk_bf16_f32 v205, v173, v189
    v_cvt_pk_bf16_f32 v206, v174, v190
    v_cvt_pk_bf16_f32 v207, v175, v191
    v_cvt_pk_bf16_f32 v208, v176, v192
    v_cvt_pk_bf16_f32 v209, v177, v193
    v_cvt_pk_bf16_f32 v210, v178, v194
    v_cvt_pk_bf16_f32 v211, v179, v195
    v_cvt_pk_bf16_f32 v212, v180, v196
    v_cvt_pk_bf16_f32 v213, v181, v197
    v_cvt_pk_bf16_f32 v214, v182, v198
    v_cvt_pk_bf16_f32 v215, v183, v199
    s_cmp_eq_u32 s23, 0
    s_cbranch_scc1 P1w0_63
    ds_write_b32 v21, v200 offset:64
    ds_write_b32 v21, v201 offset:320
    ds_write_b32 v21, v202 offset:576
    ds_write_b32 v21, v203 offset:832
    ds_write_b32 v21, v204 offset:2112
    ds_write_b32 v21, v205 offset:2368
    ds_write_b32 v21, v206 offset:2624
    ds_write_b32 v21, v207 offset:2880
    ds_write_b32 v21, v208 offset:4160
    ds_write_b32 v21, v209 offset:4416
    ds_write_b32 v21, v210 offset:4672
    ds_write_b32 v21, v211 offset:4928
    ds_write_b32 v21, v212 offset:6208
    ds_write_b32 v21, v213 offset:6464
    ds_write_b32 v21, v214 offset:6720
    ds_write_b32 v21, v215 offset:6976
    s_branch P1w1_64
P1w0_63:
    ds_write_b32 v21, v200 offset:64
    ds_write_b32 v21, v201 offset:576
    ds_write_b32 v21, v202 offset:1088
    ds_write_b32 v21, v203 offset:1600
    ds_write_b32 v21, v204 offset:4160
    ds_write_b32 v21, v205 offset:4672
    ds_write_b32 v21, v206 offset:5184
    ds_write_b32 v21, v207 offset:5696
    ds_write_b32 v22, v208 offset:5696
    ds_write_b32 v22, v209 offset:5184
    ds_write_b32 v22, v210 offset:4672
    ds_write_b32 v22, v211 offset:4160
    ds_write_b32 v22, v212 offset:1600
    ds_write_b32 v22, v213 offset:1088
    ds_write_b32 v22, v214 offset:576
    ds_write_b32 v22, v215 offset:64
    s_mov_b64 s[42:43], exec
    s_mov_b64 exec, 1
    v_mov_b32 v4, s27
    ds_write_b32 v4, v200 offset:96
    ds_write_b32 v4, v208 offset:8256
    s_mov_b64 exec, s[42:43]
P1w1_64:
    s_waitcnt lgkmcnt(0)
    s_lshl_b32 s40, s29, 2
    s_add_u32 s40, s40, s22
    s_lshl_b32 s41, s26, 1
    s_add_u32 s40, s40, s41
    s_lshl_b32 s40, s40, 6
    s_add_u32 s40, s40, s28
    ds_read_b128 v[200:203], v23 offset:0
    ds_read_b128 v[204:207], v23 offset:1024
    ds_read_b128 v[208:211], v23 offset:2048
    ds_read_b128 v[212:215], v23 offset:3072
    s_waitcnt lgkmcnt(3)
    s_add_u32 s41, s40, 0
    buffer_store_dwordx4 v[200:203], v24, s[36:39], s41 offen sc1
    ds_read_b128 v[200:203], v23 offset:4096
    s_waitcnt lgkmcnt(3)
    s_add_u32 s41, s40, 131072
    buffer_store_dwordx4 v[204:207], v24, s[36:39], s41 offen sc1
    ds_read_b128 v[204:207], v23 offset:5120
    s_waitcnt lgkmcnt(3)
    s_add_u32 s41, s40, 262144
    buffer_store_dwordx4 v[208:211], v24, s[36:39], s41 offen sc1
    ds_read_b128 v[208:211], v23 offset:6144
    s_waitcnt lgkmcnt(3)
    s_add_u32 s41, s40, 393216
    buffer_store_dwordx4 v[212:215], v24, s[36:39], s41 offen sc1
    ds_read_b128 v[212:215], v23 offset:7168
    s_waitcnt lgkmcnt(3)
    s_add_u32 s41, s40, 524288
    buffer_store_dwordx4 v[200:203], v24, s[36:39], s41 offen sc1
    s_waitcnt lgkmcnt(2)
    s_add_u32 s41, s40, 655360
    buffer_store_dwordx4 v[204:207], v24, s[36:39], s41 offen sc1
    s_waitcnt lgkmcnt(1)
    s_add_u32 s41, s40, 786432
    buffer_store_dwordx4 v[208:211], v24, s[36:39], s41 offen sc1
    s_waitcnt lgkmcnt(0)
    s_add_u32 s41, s40, 917504
    buffer_store_dwordx4 v[212:215], v24, s[36:39], s41 offen sc1
    s_cmp_eq_u32 s23, 0
    s_cbranch_scc0 P1_no9
    s_mov_b64 s[42:43], exec
    s_mov_b64 exec, 0xff
    ds_read_b128 v[200:203], v23 offset:8192
    s_waitcnt lgkmcnt(0)
    s_add_u32 s41, s40, 1048576
    buffer_store_dwordx4 v[200:203], v24, s[36:39], s41 offen sc1
    s_mov_b64 exec, s[42:43]
P1_no9:
    s_add_u32 s29, s29, 1
    s_cmp_lt_u32 s29, 2
    s_cbranch_scc0 P1_done
    s_barrier
    s_branch P1_round
P1_done:
    s_add_u32 s36, s8, 41943040
    s_addc_u32 s37, s9, 0
    s_mov_b32 s38, 4210688
    s_mov_b32 s39, 0x20000
    s_barrier
    s_cmp_eq_u32 s58, 0
    s_cbranch_scc0 W0_65
    s_lshr_b32 s41, s31, 2
    s_lshl_b32 s41, s41, 1
    v_mov_b32 v5, s41
    v_and_b32 v6, 7, v2
    v_lshlrev_b32 v7, 9, v2
    v_add_u32 v16, 0, v5
    v_xor_b32 v16, v16, v6
    v_lshl_add_u32 v16, v16, 4, v7
    v_add_u32 v17, 1, v5
    v_xor_b32 v17, v17, v6
    v_lshl_add_u32 v17, v17, 4, v7
    v_add_u32 v18, 4, v5
    v_xor_b32 v18, v18, v6
    v_lshl_add_u32 v18, v18, 4, v7
    v_add_u32 v19, 5, v5
    v_xor_b32 v19, v19, v6
    v_lshl_add_u32 v19, v19, 4, v7
    s_mov_b32 s44, 0x05040100
    s_mov_b32 s45, 0x07060302
    s_waitcnt vmcnt(0)
    v_perm_b32 v104, v64, v32, s44
    v_perm_b32 v105, v64, v32, s45
    v_perm_b32 v106, v65, v33, s44
    v_perm_b32 v107, v65, v33, s45
    v_perm_b32 v108, v66, v34, s44
    v_perm_b32 v109, v66, v34, s45
    v_perm_b32 v110, v67, v35, s44
    v_perm_b32 v111, v67, v35, s45
    ds_write_b128 v16, v[104:107] offset:0
    ds_write_b128 v17, v[108:111] offset:0
    v_perm_b32 v112, v68, v36, s44
    v_perm_b32 v113, v68, v36, s45
    v_perm_b32 v114, v69, v37, s44
    v_perm_b32 v115, v69, v37, s45
    v_perm_b32 v116, v70, v38, s44
    v_perm_b32 v117, v70, v38, s45
    v_perm_b32 v118, v71, v39, s44
    v_perm_b32 v119, v71, v39, s45
    ds_write_b128 v18, v[112:115] offset:0
    ds_write_b128 v19, v[116:119] offset:0
    v_perm_b32 v104, v72, v40, s44
    v_perm_b32 v105, v72, v40, s45
    v_perm_b32 v106, v73, v41, s44
    v_perm_b32 v107, v73, v41, s45
    v_perm_b32 v108, v74, v42, s44
    v_perm_b32 v109, v74, v42, s45
    v_perm_b32 v110, v75, v43, s44
    v_perm_b32 v111, v75, v43, s45
    ds_write_b128 v16, v[104:107] offset:128
    ds_write_b128 v17, v[108:111] offset:128
    v_perm_b32 v112, v76, v44, s44
    v_perm_b32 v113, v76, v44, s45
    v_perm_b32 v114, v77, v45, s44
    v_perm_b32 v115, v77, v45, s45
    v_perm_b32 v116, v78, v46, s44
    v_perm_b32 v117, v78, v46, s45
    v_perm_b32 v118, v79, v47, s44
    v_perm_b32 v119, v79, v47, s45
    ds_write_b128 v18, v[112:115] offset:128
    ds_write_b128 v19, v[116:119] offset:128
    v_perm_b32 v104, v80, v48, s44
    v_perm_b32 v105, v80, v48, s45
    v_perm_b32 v106, v81, v49, s44
    v_perm_b32 v107, v81, v49, s45
    v_perm_b32 v108, v82, v50, s44
    v_perm_b32 v109, v82, v50, s45
    v_perm_b32 v110, v83, v51, s44
    v_perm_b32 v111, v83, v51, s45
    ds_write_b128 v16, v[104:107] offset:256
    ds_write_b128 v17, v[108:111] offset:256
    v_perm_b32 v112, v84, v52, s44
    v_perm_b32 v113, v84, v52, s45
    v_perm_b32 v114, v85, v53, s44
    v_perm_b32 v115, v85, v53, s45
    v_perm_b32 v116, v86, v54, s44
    v_perm_b32 v117, v86, v54, s45
    v_perm_b32 v118, v87, v55, s44
    v_perm_b32 v119, v87, v55, s45
    ds_write_b128 v18, v[112:115] offset:256
    ds_write_b128 v19, v[116:119] offset:256
    v_perm_b32 v104, v88, v56, s44
    v_perm_b32 v105, v88, v56, s45
    v_perm_b32 v106, v89, v57, s44
    v_perm_b32 v107, v89, v57, s45
    v_perm_b32 v108, v90, v58, s44
    v_perm_b32 v109, v90, v58, s45
    v_perm_b32 v110, v91, v59, s44
    v_perm_b32 v111, v91, v59, s45
    ds_write_b128 v16, v[104:107] offset:384
    ds_write_b128 v17, v[108:111] offset:384
    v_perm_b32 v112, v92, v60, s44
    v_perm_b32 v113, v92, v60, s45
    v_perm_b32 v114, v93, v61, s44
    v_perm_b32 v115, v93, v61, s45
    v_perm_b32 v116, v94, v62, s44
    v_perm_b32 v117, v94, v62, s45
    v_perm_b32 v118, v95, v63, s44
    v_perm_b32 v119, v95, v63, s45
    ds_write_b128 v18, v[112:115] offset:384
    ds_write_b128 v19, v[116:119] offset:384
    v_lshlrev_b32 v248, 16, v248
    v_lshlrev_b32 v249, 16, v249
    v_lshlrev_b32 v250, 16, v250
    v_lshlrev_b32 v251, 16, v251
    v_lshlrev_b32 v252, 16, v252
    v_lshlrev_b32 v253, 16, v253
    v_lshlrev_b32 v254, 16, v254
    v_lshlrev_b32 v255, 16, v255
    v_add_f32 v4, v248, v252
    v_sub_f32 v5, v249, v253
    v_mul_f32 v4, 0.5, v4
    v_mul_f32 v5, 0.5, v5
    v_cvt_pk_bf16_f32 v120, v4, v5
    v_add_f32 v4, v250, v254
    v_sub_f32 v5, v251, v255
    v_mul_f32 v4, 0.5, v4
    v_mul_f32 v5, 0.5, v5
    v_cvt_pk_bf16_f32 v121, v4, v5
    s_mov_b64 exec, 0xff
    v_lshlrev_b32 v4, 6, v2
    s_lshr_b32 s41, s31, 2
    s_lshl_b32 s41, s41, 5
    v_add_u32 v4, s41, v4
    ds_write_b32 v4, v120
    ds_write_b32 v4, v121 offset:32768
    s_mov_b64 exec, -1
    s_waitcnt lgkmcnt(0)
W0_65:
    s_barrier
    v_lshrrev_b32 v4, 5, v2
    v_and_b32 v5, 31, v2
    v_lshlrev_b32 v6, 14, v4
    v_lshl_add_u32 v15, v5, 4, v6
    v_xor_b32 v5, v5, v4
    v_lshlrev_b32 v5, 4, v5
    v_lshlrev_b32 v6, 9, v4
    s_lshl_b32 s46, s31, 12
    v_add_u32 v6, s46, v6
    s_lshl_b32 s47, s31, 17
    s_add_u32 s47, s47, 3145728
    s_lshl_b32 s40, s22, 6
    s_add_u32 s47, s47, s40
    v_xor_b32 v14, 0, v5
    v_add_u32 v14, v14, v6
    ds_read_b128 v[104:107], v14 offset:0
    v_xor_b32 v14, 32, v5
    v_add_u32 v14, v14, v6
    ds_read_b128 v[108:111], v14 offset:1024
    v_xor_b32 v14, 64, v5
    v_add_u32 v14, v14, v6
    ds_read_b128 v[112:115], v14 offset:2048
    v_xor_b32 v14, 96, v5
    v_add_u32 v14, v14, v6
    ds_read_b128 v[116:119], v14 offset:3072
    s_waitcnt lgkmcnt(3)
    s_add_u32 s40, s47, 0
    buffer_store_dwordx4 v[104:107], v15, s[36:39], s40 offen sc1
    s_waitcnt lgkmcnt(2)
    s_add_u32 s40, s47, 32768
    buffer_store_dwordx4 v[108:111], v15, s[36:39], s40 offen sc1
    s_waitcnt lgkmcnt(1)
    s_add_u32 s40, s47, 65536
    buffer_store_dwordx4 v[112:115], v15, s[36:39], s40 offen sc1
    s_waitcnt lgkmcnt(0)
    s_add_u32 s40, s47, 98304
    buffer_store_dwordx4 v[116:119], v15, s[36:39], s40 offen sc1
    s_cmp_eq_u32 s31, 0
    s_cbranch_scc0 W0_66
    s_mov_b32 exec_hi, 0
    v_add_u32 v14, v5, v6
    ds_read_b128 v[104:107], v14 offset:32768
    s_waitcnt lgkmcnt(0)
    s_lshl_b32 s40, s22, 6
    s_add_u32 s40, s40, 4194304
    buffer_store_dwordx4 v[104:107], v15, s[36:39], s40 offen sc1
    s_mov_b64 exec, -1
W0_66:
FFT_STORES_END:
    s_waitcnt vmcnt(0)
    s_barrier
    s_sub_u32 s30, s31, 4
    s_mov_b32 s34, 0
    s_cmp_lt_u32 s31, 4
    s_cbranch_scc1 F_p2cons
    s_cmp_eq_u32 s31, 4
    s_cbranch_scc0 Only_67
    s_load_dwordx2 s[44:45], s[0:1], 64
    s_waitcnt lgkmcnt(0)
    s_mov_b32 s46, 256
    s_mov_b32 s47, 0x20000
    v_mov_b32 v4, 0
    s_mov_b32 s41, 0
PI_68:
    buffer_load_dword v5, v4, s[44:47], 0 offen sc1
    s_waitcnt vmcnt(0)
    v_readfirstlane_b32 s40, v5
    s_add_u32 s41, s41, 1
    s_cmp_ge_u32 s40, 1
    s_cbranch_scc1 PID_69
    s_cmp_ge_u32 s41, 100000
    s_cbranch_scc1 PID_69
    s_sleep 2
    s_branch PI_68
PID_69:
    v_mbcnt_lo_u32_b32 v4, -1, 0
    v_mbcnt_hi_u32_b32 v4, -1, v4
    v_lshlrev_b32 v4, 7, v4
    v_add_u32 v4, 0, v4
    v_mov_b32 v5, 1
    s_mov_b64 exec, 255
    buffer_atomic_add v5, v4, s[96:99], 0 offen
    s_mov_b64 exec, -1
Only_67:
    s_mov_b32 s34, 0
    s_mov_b32 s33, 0
    s_mov_b32 s32, 1000
F_common1:
    s_load_dwordx2 s[6:7], s[0:1], 40
    s_waitcnt lgkmcnt(0)
    s_mov_b32 s16, s6
    s_mov_b32 s17, s7
    s_mov_b32 s18, 7340032
    s_mov_b32 s19, 0x20000
    s_cmp_eq_u32 s34, 1
    s_cbranch_scc1 ww_70
    s_lshl_b32 s50, s2, 2
    s_add_u32 s50, s50, s30
    s_mul_i32 s50, s50, 7168
    v_lshlrev_b32 v16, 4, v2
    s_add_u32 s40, s50, 0
    buffer_load_dwordx4 v[200:203], v16, s[16:19], s40 offen
    s_add_u32 s40, s50, 1024
    buffer_load_dwordx4 v[204:207], v16, s[16:19], s40 offen
    s_add_u32 s40, s50, 2048
    buffer_load_dwordx4 v[208:211], v16, s[16:19], s40 offen
    s_add_u32 s40, s50, 3072
    buffer_load_dwordx4 v[212:215], v16, s[16:19], s40 offen
    s_add_u32 s40, s50, 4096
    buffer_load_dwordx4 v[216:219], v16, s[16:19], s40 offen
    s_add_u32 s40, s50, 5120
    buffer_load_dwordx4 v[220:223], v16, s[16:19], s40 offen
    s_add_u32 s40, s50, 6144
    buffer_load_dwordx4 v[224:227], v16, s[16:19], s40 offen
ww_70:
    v_and_b32 v4, 31, v2
    v_lshrrev_b32 v5, 5, v2
    v_lshlrev_b32 v5, 2, v5
    s_mov_b32 s40, 1023410176
    v_add_u32 v6, 0, v5
    v_mul_u32_u24 v6, v6, v4
    v_and_b32 v6, 31, v6
    v_cvt_f32_u32 v6, v6
    v_mul_f32 v6, s40, v6
    v_cos_f32 v7, v6
    v_sin_f32 v8, v6
    s_nop 0
    v_cvt_pk_bf16_f32 v80, v7, -v8
    v_cvt_pk_bf16_f32 v96, v8, v7
    v_add_u32 v6, 1, v5
    v_mul_u32_u24 v6, v6, v4
    v_and_b32 v6, 31, v6
    v_cvt_f32_u32 v6, v6
    v_mul_f32 v6, s40, v6
    v_cos_f32 v7, v6
    v_sin_f32 v8, v6
    s_nop 0
    v_cvt_pk_bf16_f32 v81, v7, -v8
    v_cvt_pk_bf16_f32 v97, v8, v7
    v_add_u32 v6, 2, v5
    v_mul_u32_u24 v6, v6, v4
    v_and_b32 v6, 31, v6
    v_cvt_f32_u32 v6, v6
    v_mul_f32 v6, s40, v6
    v_cos_f32 v7, v6
    v_sin_f32 v8, v6
    s_nop 0
    v_cvt_pk_bf16_f32 v82, v7, -v8
    v_cvt_pk_bf16_f32 v98, v8, v7
    v_add_u32 v6, 3, v5
    v_mul_u32_u24 v6, v6, v4
    v_and_b32 v6, 31, v6
    v_cvt_f32_u32 v6, v6
    v_mul_f32 v6, s40, v6
    v_cos_f32 v7, v6
    v_sin_f32 v8, v6
    s_nop 0
    v_cvt_pk_bf16_f32 v83, v7, -v8
    v_cvt_pk_bf16_f32 v99, v8, v7
    v_add_u32 v6, 8, v5
    v_mul_u32_u24 v6, v6, v4
    v_and_b32 v6, 31, v6
    v_cvt_f32_u32 v6, v6
    v_mul_f32 v6, s40, v6
    v_cos_f32 v7, v6
    v_sin_f32 v8, v6
    s_nop 0
    v_cvt_pk_bf16_f32 v84, v7, -v8
    v_cvt_pk_bf16_f32 v100, v8, v7
    v_add_u32 v6, 9, v5
    v_mul_u32_u24 v6, v6, v4
    v_and_b32 v6, 31, v6
    v_cvt_f32_u32 v6, v6
    v_mul_f32 v6, s40, v6
    v_cos_f32 v7, v6
    v_sin_f32 v8, v6
    s_nop 0
    v_cvt_pk_bf16_f32 v85, v7, -v8
    v_cvt_pk_bf16_f32 v101, v8, v7
    v_add_u32 v6, 10, v5
    v_mul_u32_u24 v6, v6, v4
    v_and_b32 v6, 31, v6
    v_cvt_f32_u32 v6, v6
    v_mul_f32 v6, s40, v6
    v_cos_f32 v7, v6
    v_sin_f32 v8, v6
    s_nop 0
    v_cvt_pk_bf16_f32 v86, v7, -v8
    v_cvt_pk_bf16_f32 v102, v8, v7
    v_add_u32 v6, 11, v5
    v_mul_u32_u24 v6, v6, v4
    v_and_b32 v6, 31, v6
    v_cvt_f32_u32 v6, v6
    v_mul_f32 v6, s40, v6
    v_cos_f32 v7, v6
    v_sin_f32 v8, v6
    s_nop 0
    v_cvt_pk_bf16_f32 v87, v7, -v8
    v_cvt_pk_bf16_f32 v103, v8, v7
    v_add_u32 v6, 16, v5
    v_mul_u32_u24 v6, v6, v4
    v_and_b32 v6, 31, v6
    v_cvt_f32_u32 v6, v6
    v_mul_f32 v6, s40, v6
    v_cos_f32 v7, v6
    v_sin_f32 v8, v6
    s_nop 0
    v_cvt_pk_bf16_f32 v88, v7, -v8
    v_cvt_pk_bf16_f32 v104, v8, v7
    v_add_u32 v6, 17, v5
    v_mul_u32_u24 v6, v6, v4
    v_and_b32 v6, 31, v6
    v_cvt_f32_u32 v6, v6
    v_mul_f32 v6, s40, v6
    v_cos_f32 v7, v6
    v_sin_f32 v8, v6
    s_nop 0
    v_cvt_pk_bf16_f32 v89, v7, -v8
    v_cvt_pk_bf16_f32 v105, v8, v7
    v_add_u32 v6, 18, v5
    v_mul_u32_u24 v6, v6, v4
    v_and_b32 v6, 31, v6
    v_cvt_f32_u32 v6, v6
    v_mul_f32 v6, s40, v6
    v_cos_f32 v7, v6
    v_sin_f32 v8, v6
    s_nop 0
    v_cvt_pk_bf16_f32 v90, v7, -v8
    v_cvt_pk_bf16_f32 v106, v8, v7
    v_add_u32 v6, 19, v5
    v_mul_u32_u24 v6, v6, v4
    v_and_b32 v6, 31, v6
    v_cvt_f32_u32 v6, v6
    v_mul_f32 v6, s40, v6
    v_cos_f32 v7, v6
    v_sin_f32 v8, v6
    s_nop 0
    v_cvt_pk_bf16_f32 v91, v7, -v8
    v_cvt_pk_bf16_f32 v107, v8, v7
    v_add_u32 v6, 24, v5
    v_mul_u32_u24 v6, v6, v4
    v_and_b32 v6, 31, v6
    v_cvt_f32_u32 v6, v6
    v_mul_f32 v6, s40, v6
    v_cos_f32 v7, v6
    v_sin_f32 v8, v6
    s_nop 0
    v_cvt_pk_bf16_f32 v92, v7, -v8
    v_cvt_pk_bf16_f32 v108, v8, v7
    v_add_u32 v6, 25, v5
    v_mul_u32_u24 v6, v6, v4
    v_and_b32 v6, 31, v6
    v_cvt_f32_u32 v6, v6
    v_mul_f32 v6, s40, v6
    v_cos_f32 v7, v6
    v_sin_f32 v8, v6
    s_nop 0
    v_cvt_pk_bf16_f32 v93, v7, -v8
    v_cvt_pk_bf16_f32 v109, v8, v7
    v_add_u32 v6, 26, v5
    v_mul_u32_u24 v6, v6, v4
    v_and_b32 v6, 31, v6
    v_cvt_f32_u32 v6, v6
    v_mul_f32 v6, s40, v6
    v_cos_f32 v7, v6
    v_sin_f32 v8, v6
    s_nop 0
    v_cvt_pk_bf16_f32 v94, v7, -v8
    v_cvt_pk_bf16_f32 v110, v8, v7
    v_add_u32 v6, 27, v5
    v_mul_u32_u24 v6, v6, v4
    v_and_b32 v6, 31, v6
    v_cvt_f32_u32 v6, v6
    v_mul_f32 v6, s40, v6
    v_cos_f32 v7, v6
    v_sin_f32 v8, v6
    s_nop 0
    v_cvt_pk_bf16_f32 v95, v7, -v8
    v_cvt_pk_bf16_f32 v111, v8, v7
    s_mov_b32 s41, 897581056
    s_mov_b32 s35, 889192448
    s_cmp_eq_u32 s30, 0
    s_cselect_b32 s35, s35, s41
    v_and_b32 v4, 31, v2
    v_lshrrev_b32 v5, 5, v2
    v_lshlrev_b32 v5, 2, v5
    s_mov_b32 s40, 981467136
    v_add_u32 v6, 0, v5
    v_mul_u32_u24 v6, v6, v4
    v_cvt_f32_u32 v6, v6
    v_mul_f32 v6, s40, v6
    v_cos_f32 v112, v6
    v_sin_f32 v128, v6
    v_add_u32 v6, 1, v5
    v_mul_u32_u24 v6, v6, v4
    v_cvt_f32_u32 v6, v6
    v_mul_f32 v6, s40, v6
    v_cos_f32 v113, v6
    v_sin_f32 v129, v6
    v_add_u32 v6, 2, v5
    v_mul_u32_u24 v6, v6, v4
    v_cvt_f32_u32 v6, v6
    v_mul_f32 v6, s40, v6
    v_cos_f32 v114, v6
    v_sin_f32 v130, v6
    v_add_u32 v6, 3, v5
    v_mul_u32_u24 v6, v6, v4
    v_cvt_f32_u32 v6, v6
    v_mul_f32 v6, s40, v6
    v_cos_f32 v115, v6
    v_sin_f32 v131, v6
    v_add_u32 v6, 8, v5
    v_mul_u32_u24 v6, v6, v4
    v_cvt_f32_u32 v6, v6
    v_mul_f32 v6, s40, v6
    v_cos_f32 v116, v6
    v_sin_f32 v132, v6
    v_add_u32 v6, 9, v5
    v_mul_u32_u24 v6, v6, v4
    v_cvt_f32_u32 v6, v6
    v_mul_f32 v6, s40, v6
    v_cos_f32 v117, v6
    v_sin_f32 v133, v6
    v_add_u32 v6, 10, v5
    v_mul_u32_u24 v6, v6, v4
    v_cvt_f32_u32 v6, v6
    v_mul_f32 v6, s40, v6
    v_cos_f32 v118, v6
    v_sin_f32 v134, v6
    v_add_u32 v6, 11, v5
    v_mul_u32_u24 v6, v6, v4
    v_cvt_f32_u32 v6, v6
    v_mul_f32 v6, s40, v6
    v_cos_f32 v119, v6
    v_sin_f32 v135, v6
    v_add_u32 v6, 16, v5
    v_mul_u32_u24 v6, v6, v4
    v_cvt_f32_u32 v6, v6
    v_mul_f32 v6, s40, v6
    v_cos_f32 v120, v6
    v_sin_f32 v136, v6
    v_add_u32 v6, 17, v5
    v_mul_u32_u24 v6, v6, v4
    v_cvt_f32_u32 v6, v6
    v_mul_f32 v6, s40, v6
    v_cos_f32 v121, v6
    v_sin_f32 v137, v6
    v_add_u32 v6, 18, v5
    v_mul_u32_u24 v6, v6, v4
    v_cvt_f32_u32 v6, v6
    v_mul_f32 v6, s40, v6
    v_cos_f32 v122, v6
    v_sin_f32 v138, v6
    v_add_u32 v6, 19, v5
    v_mul_u32_u24 v6, v6, v4
    v_cvt_f32_u32 v6, v6
    v_mul_f32 v6, s40, v6
    v_cos_f32 v123, v6
    v_sin_f32 v139, v6
    v_add_u32 v6, 24, v5
    v_mul_u32_u24 v6, v6, v4
    v_cvt_f32_u32 v6, v6
    v_mul_f32 v6, s40, v6
    v_cos_f32 v124, v6
    v_sin_f32 v140, v6
    v_add_u32 v6, 25, v5
    v_mul_u32_u24 v6, v6, v4
    v_cvt_f32_u32 v6, v6
    v_mul_f32 v6, s40, v6
    v_cos_f32 v125, v6
    v_sin_f32 v141, v6
    v_add_u32 v6, 26, v5
    v_mul_u32_u24 v6, v6, v4
    v_cvt_f32_u32 v6, v6
    v_mul_f32 v6, s40, v6
    v_cos_f32 v126, v6
    v_sin_f32 v142, v6
    v_add_u32 v6, 27, v5
    v_mul_u32_u24 v6, v6, v4
    v_cvt_f32_u32 v6, v6
    v_mul_f32 v6, s40, v6
    v_cos_f32 v127, v6
    v_sin_f32 v143, v6
    s_mov_b32 s40, s35
    s_nop 0
    v_mul_f32 v112, s40, v112
    v_mul_f32 v128, s40, v128
    v_mul_f32 v113, s40, v113
    v_mul_f32 v129, s40, v129
    v_mul_f32 v114, s40, v114
    v_mul_f32 v130, s40, v130
    v_mul_f32 v115, s40, v115
    v_mul_f32 v131, s40, v131
    v_mul_f32 v116, s40, v116
    v_mul_f32 v132, s40, v132
    v_mul_f32 v117, s40, v117
    v_mul_f32 v133, s40, v133
    v_mul_f32 v118, s40, v118
    v_mul_f32 v134, s40, v134
    v_mul_f32 v119, s40, v119
    v_mul_f32 v135, s40, v135
    v_mul_f32 v120, s40, v120
    v_mul_f32 v136, s40, v136
    v_mul_f32 v121, s40, v121
    v_mul_f32 v137, s40, v137
    v_mul_f32 v122, s40, v122
    v_mul_f32 v138, s40, v138
    v_mul_f32 v123, s40, v123
    v_mul_f32 v139, s40, v139
    v_mul_f32 v124, s40, v124
    v_mul_f32 v140, s40, v140
    v_mul_f32 v125, s40, v125
    v_mul_f32 v141, s40, v141
    v_mul_f32 v126, s40, v126
    v_mul_f32 v142, s40, v142
    v_mul_f32 v127, s40, v127
    v_mul_f32 v143, s40, v143
F_p2load:
    s_lshr_b32 s25, s20, 2
    s_and_b32 s22, s20, 1
    s_lshl_b32 s22, s22, 3
    s_and_b32 s23, s21, 7
    s_add_u32 s22, s22, s23
    s_bfe_u32 s23, s20, 0x10001
    s_lshl_b32 s23, s23, 2
    s_lshr_b32 s24, s21, 3
    s_add_u32 s23, s23, s24
    s_mov_b32 s12, s8
    s_mov_b32 s13, s9
    s_mov_b32 s14, 14680064
    s_mov_b32 s15, 0x20000
    s_add_u32 s36, s8, 16777216
    s_addc_u32 s37, s9, 0
    s_mov_b32 s38, 4210688
    s_mov_b32 s39, 0x20000
    s_add_u32 s52, s8, 41943040
    s_addc_u32 s53, s9, 0
    s_mov_b32 s54, 4210688
    s_mov_b32 s55, 0x20000
    s_add_u32 s56, s8, 25165824
    s_addc_u32 s57, s9, 0
    s_mov_b32 s58, 4210688
    s_mov_b32 s59, 0x20000
    s_cmp_eq_u32 s30, 0
    s_cbranch_scc0 Only_71
    v_mov_b32 v4, 98300
    v_mov_b32 v5, 0
    ds_write_b32 v4, v5
    s_waitcnt lgkmcnt(0)
Only_71:
    s_mul_i32 s28, s22, 917504
    s_mul_i32 s29, s25, 57344
    s_add_u32 s28, s28, s29
    s_mul_i32 s29, s25, 3670016
    s_lshl_b32 s26, s23, 8
    s_add_u32 s29, s29, s26
    s_lshr_b32 s40, s30, 1
    s_mul_i32 s40, s40, 114688
    s_and_b32 s41, s30, 1
    s_lshl_b32 s41, s41, 10
    s_add_u32 s40, s40, s41
    v_lshlrev_b32 v10, 4, v2
    v_add_u32 v10, s40, v10
    v_lshrrev_b32 v12, 4, v2
    s_mov_b32 s40, s30
    s_and_b32 s40, s40, 1
    s_lshl_b32 s40, s40, 2
    v_or_b32 v13, s40, v12
    s_lshl_b32 s41, s30, 2
    v_add_u32 v12, s41, v12
    s_mov_b32 s41, 2048
    v_mul_lo_u32 v12, v12, s41
    v_and_b32 v11, 15, v2
    v_lshrrev_b32 v14, 1, v11
    v_xor_b32 v14, v14, v13
    v_lshlrev_b32 v14, 5, v14
    v_and_b32 v11, 1, v11
    v_lshlrev_b32 v11, 4, v11
    v_add3_u32 v11, v11, v14, v12
    s_lshl_b32 s42, s30, 10
    s_mov_b32 s43, 0
    s_mov_b32 s44, s28
    s_mov_b32 s45, s29
    v_lshrrev_b32 v4, 2, v2
    v_lshlrev_b32 v4, 6, v4
    v_lshrrev_b32 v5, 4, v2
    v_and_b32 v6, 3, v2
    v_xor_b32 v5, v5, v6
    v_lshl_add_u32 v17, v5, 4, v4
    v_lshlrev_b32 v18, 4, v2
    s_lshl_b32 s40, s30, 12
    s_add_u32 s40, s40, 98304
    v_add_u32 v18, s40, v18
    s_mov_b32 s27, s2
    s_cmp_eq_u32 s2, 255
    s_cselect_b32 s26, 256, s2
    s_mov_b32 s49, 0
    s_lshl_b32 s62, s20, 7
    s_cmp_eq_u32 s30, 0
    s_cbranch_scc0 Only_72
    s_cmp_eq_u32 s34, 1
    s_cbranch_scc0 W4_73
    s_add_u32 s40, s62, 0
    v_mov_b32 v4, s40
    buffer_load_dword v5, v4, s[96:99], 0 offen sc1
    s_waitcnt vmcnt(0)
    v_readfirstlane_b32 s40, v5
    s_cmp_ge_u32 s40, 32
    s_cbranch_scc0 W4_73
    s_lshl_b32 s40, s26, 14
    s_mov_b32 m0, 98304
    s_add_u32 s41, s40, 0
    buffer_load_dwordx4 v17, s[36:39], s41 offen sc1 lds
    s_mov_b32 m0, 99328
    s_add_u32 s41, s40, 1024
    buffer_load_dwordx4 v17, s[36:39], s41 offen sc1 lds
    s_mov_b32 m0, 100352
    s_add_u32 s41, s40, 2048
    buffer_load_dwordx4 v17, s[36:39], s41 offen sc1 lds
    s_mov_b32 m0, 101376
    s_add_u32 s41, s40, 3072
    buffer_load_dwordx4 v17, s[36:39], s41 offen sc1 lds
    s_mov_b32 m0, 102400
    s_add_u32 s41, s40, 4096
    buffer_load_dwordx4 v17, s[36:39], s41 offen sc1 lds
    s_mov_b32 m0, 103424
    s_add_u32 s41, s40, 5120
    buffer_load_dwordx4 v17, s[36:39], s41 offen sc1 lds
    s_mov_b32 m0, 104448
    s_add_u32 s41, s40, 6144
    buffer_load_dwordx4 v17, s[36:39], s41 offen sc1 lds
    s_mov_b32 m0, 105472
    s_add_u32 s41, s40, 7168
    buffer_load_dwordx4 v17, s[36:39], s41 offen sc1 lds
    s_mov_b32 m0, 106496
    s_add_u32 s41, s40, 8192
    buffer_load_dwordx4 v17, s[36:39], s41 offen sc1 lds
    s_mov_b32 m0, 107520
    s_add_u32 s41, s40, 9216
    buffer_load_dwordx4 v17, s[36:39], s41 offen sc1 lds
    s_mov_b32 m0, 108544
    s_add_u32 s41, s40, 10240
    buffer_load_dwordx4 v17, s[36:39], s41 offen sc1 lds
    s_mov_b32 m0, 109568
    s_add_u32 s41, s40, 11264
    buffer_load_dwordx4 v17, s[36:39], s41 offen sc1 lds
    s_mov_b32 m0, 110592
    s_add_u32 s41, s40, 12288
    buffer_load_dwordx4 v17, s[36:39], s41 offen sc1 lds
    s_mov_b32 m0, 111616
    s_add_u32 s41, s40, 13312
    buffer_load_dwordx4 v17, s[36:39], s41 offen sc1 lds
    s_mov_b32 m0, 112640
    s_add_u32 s41, s40, 14336
    buffer_load_dwordx4 v17, s[36:39], s41 offen sc1 lds
    s_mov_b32 m0, 113664
    s_add_u32 s41, s40, 15360
    buffer_load_dwordx4 v17, s[36:39], s41 offen sc1 lds
    s_cmp_ge_u32 s26, 192
    s_cbranch_scc0 td_74
    s_lshl_b32 s40, s26, 14
    s_mov_b32 m0, 114688
    s_add_u32 s41, s40, 0
    buffer_load_dwordx4 v17, s[52:55], s41 offen sc1 lds
    s_mov_b32 m0, 115712
    s_add_u32 s41, s40, 1024
    buffer_load_dwordx4 v17, s[52:55], s41 offen sc1 lds
    s_mov_b32 m0, 116736
    s_add_u32 s41, s40, 2048
    buffer_load_dwordx4 v17, s[52:55], s41 offen sc1 lds
    s_mov_b32 m0, 117760
    s_add_u32 s41, s40, 3072
    buffer_load_dwordx4 v17, s[52:55], s41 offen sc1 lds
    s_mov_b32 m0, 118784
    s_add_u32 s41, s40, 4096
    buffer_load_dwordx4 v17, s[52:55], s41 offen sc1 lds
    s_mov_b32 m0, 119808
    s_add_u32 s41, s40, 5120
    buffer_load_dwordx4 v17, s[52:55], s41 offen sc1 lds
    s_mov_b32 m0, 120832
    s_add_u32 s41, s40, 6144
    buffer_load_dwordx4 v17, s[52:55], s41 offen sc1 lds
    s_mov_b32 m0, 121856
    s_add_u32 s41, s40, 7168
    buffer_load_dwordx4 v17, s[52:55], s41 offen sc1 lds
    s_mov_b32 m0, 122880
    s_add_u32 s41, s40, 8192
    buffer_load_dwordx4 v17, s[52:55], s41 offen sc1 lds
    s_mov_b32 m0, 123904
    s_add_u32 s41, s40, 9216
    buffer_load_dwordx4 v17, s[52:55], s41 offen sc1 lds
    s_mov_b32 m0, 124928
    s_add_u32 s41, s40, 10240
    buffer_load_dwordx4 v17, s[52:55], s41 offen sc1 lds
    s_mov_b32 m0, 125952
    s_add_u32 s41, s40, 11264
    buffer_load_dwordx4 v17, s[52:55], s41 offen sc1 lds
    s_mov_b32 m0, 126976
    s_add_u32 s41, s40, 12288
    buffer_load_dwordx4 v17, s[52:55], s41 offen sc1 lds
    s_mov_b32 m0, 128000
    s_add_u32 s41, s40, 13312
    buffer_load_dwordx4 v17, s[52:55], s41 offen sc1 lds
    s_mov_b32 m0, 129024
    s_add_u32 s41, s40, 14336
    buffer_load_dwordx4 v17, s[52:55], s41 offen sc1 lds
    s_mov_b32 m0, 130048
    s_add_u32 s41, s40, 15360
    buffer_load_dwordx4 v17, s[52:55], s41 offen sc1 lds
td_74:
    s_mov_b32 s49, 1
W4_73:
Only_72:
    s_cmp_eq_u32 s34, 1
    s_cbranch_scc0 noX0_75
    s_barrier
    s_cmp_eq_u32 s30, 0
    s_cbranch_scc0 Only_76
    v_mbcnt_lo_u32_b32 v4, -1, 0
    v_mbcnt_hi_u32_b32 v4, -1, v4
    v_lshlrev_b32 v4, 7, v4
    s_add_u32 s40, s33, 2048
    v_add_u32 v4, s40, v4
    v_mov_b32 v5, 1
    s_mov_b64 exec, 1
    buffer_atomic_add v5, v4, s[96:99], 0 offen
    s_mov_b64 exec, -1
Only_76:
noX0_75:
F_passL:
    s_cmp_eq_u32 s30, 0
    s_cbranch_scc0 Only_77
    s_cmp_ge_u32 s49, 1
    s_cbranch_scc1 W4_78
    s_add_u32 s40, s62, 0
    v_mov_b32 v4, s40
    s_mov_b32 s41, 0
Poll_79:
    buffer_load_dword v5, v4, s[96:99], 0 offen sc1
    s_waitcnt vmcnt(0)
    v_readfirstlane_b32 s40, v5
    s_add_u32 s41, s41, 1
    s_cmp_ge_u32 s40, 32
    s_cbranch_scc1 PollD_80
    s_cmp_ge_u32 s41, 100000
    s_cbranch_scc1 PollD_80
    s_sleep 2
    s_branch Poll_79
PollD_80:
    s_lshl_b32 s40, s26, 14
    s_mov_b32 m0, 98304
    s_add_u32 s41, s40, 0
    buffer_load_dwordx4 v17, s[36:39], s41 offen sc1 lds
    s_mov_b32 m0, 99328
    s_add_u32 s41, s40, 1024
    buffer_load_dwordx4 v17, s[36:39], s41 offen sc1 lds
    s_mov_b32 m0, 100352
    s_add_u32 s41, s40, 2048
    buffer_load_dwordx4 v17, s[36:39], s41 offen sc1 lds
    s_mov_b32 m0, 101376
    s_add_u32 s41, s40, 3072
    buffer_load_dwordx4 v17, s[36:39], s41 offen sc1 lds
    s_mov_b32 m0, 102400
    s_add_u32 s41, s40, 4096
    buffer_load_dwordx4 v17, s[36:39], s41 offen sc1 lds
    s_mov_b32 m0, 103424
    s_add_u32 s41, s40, 5120
    buffer_load_dwordx4 v17, s[36:39], s41 offen sc1 lds
    s_mov_b32 m0, 104448
    s_add_u32 s41, s40, 6144
    buffer_load_dwordx4 v17, s[36:39], s41 offen sc1 lds
    s_mov_b32 m0, 105472
    s_add_u32 s41, s40, 7168
    buffer_load_dwordx4 v17, s[36:39], s41 offen sc1 lds
    s_mov_b32 m0, 106496
    s_add_u32 s41, s40, 8192
    buffer_load_dwordx4 v17, s[36:39], s41 offen sc1 lds
    s_mov_b32 m0, 107520
    s_add_u32 s41, s40, 9216
    buffer_load_dwordx4 v17, s[36:39], s41 offen sc1 lds
    s_mov_b32 m0, 108544
    s_add_u32 s41, s40, 10240
    buffer_load_dwordx4 v17, s[36:39], s41 offen sc1 lds
    s_mov_b32 m0, 109568
    s_add_u32 s41, s40, 11264
    buffer_load_dwordx4 v17, s[36:39], s41 offen sc1 lds
    s_mov_b32 m0, 110592
    s_add_u32 s41, s40, 12288
    buffer_load_dwordx4 v17, s[36:39], s41 offen sc1 lds
    s_mov_b32 m0, 111616
    s_add_u32 s41, s40, 13312
    buffer_load_dwordx4 v17, s[36:39], s41 offen sc1 lds
    s_mov_b32 m0, 112640
    s_add_u32 s41, s40, 14336
    buffer_load_dwordx4 v17, s[36:39], s41 offen sc1 lds
    s_mov_b32 m0, 113664
    s_add_u32 s41, s40, 15360
    buffer_load_dwordx4 v17, s[36:39], s41 offen sc1 lds
    s_cmp_ge_u32 s26, 192
    s_cbranch_scc0 td_81
    s_lshl_b32 s40, s26, 14
    s_mov_b32 m0, 114688
    s_add_u32 s41, s40, 0
    buffer_load_dwordx4 v17, s[52:55], s41 offen sc1 lds
    s_mov_b32 m0, 115712
    s_add_u32 s41, s40, 1024
    buffer_load_dwordx4 v17, s[52:55], s41 offen sc1 lds
    s_mov_b32 m0, 116736
    s_add_u32 s41, s40, 2048
    buffer_load_dwordx4 v17, s[52:55], s41 offen sc1 lds
    s_mov_b32 m0, 117760
    s_add_u32 s41, s40, 3072
    buffer_load_dwordx4 v17, s[52:55], s41 offen sc1 lds
    s_mov_b32 m0, 118784
    s_add_u32 s41, s40, 4096
    buffer_load_dwordx4 v17, s[52:55], s41 offen sc1 lds
    s_mov_b32 m0, 119808
    s_add_u32 s41, s40, 5120
    buffer_load_dwordx4 v17, s[52:55], s41 offen sc1 lds
    s_mov_b32 m0, 120832
    s_add_u32 s41, s40, 6144
    buffer_load_dwordx4 v17, s[52:55], s41 offen sc1 lds
    s_mov_b32 m0, 121856
    s_add_u32 s41, s40, 7168
    buffer_load_dwordx4 v17, s[52:55], s41 offen sc1 lds
    s_mov_b32 m0, 122880
    s_add_u32 s41, s40, 8192
    buffer_load_dwordx4 v17, s[52:55], s41 offen sc1 lds
    s_mov_b32 m0, 123904
    s_add_u32 s41, s40, 9216
    buffer_load_dwordx4 v17, s[52:55], s41 offen sc1 lds
    s_mov_b32 m0, 124928
    s_add_u32 s41, s40, 10240
    buffer_load_dwordx4 v17, s[52:55], s41 offen sc1 lds
    s_mov_b32 m0, 125952
    s_add_u32 s41, s40, 11264
    buffer_load_dwordx4 v17, s[52:55], s41 offen sc1 lds
    s_mov_b32 m0, 126976
    s_add_u32 s41, s40, 12288
    buffer_load_dwordx4 v17, s[52:55], s41 offen sc1 lds
    s_mov_b32 m0, 128000
    s_add_u32 s41, s40, 13312
    buffer_load_dwordx4 v17, s[52:55], s41 offen sc1 lds
    s_mov_b32 m0, 129024
    s_add_u32 s41, s40, 14336
    buffer_load_dwordx4 v17, s[52:55], s41 offen sc1 lds
    s_mov_b32 m0, 130048
    s_add_u32 s41, s40, 15360
    buffer_load_dwordx4 v17, s[52:55], s41 offen sc1 lds
td_81:
W4_78:
    s_waitcnt vmcnt(0)
Only_77:
    s_barrier
    s_cmp_eq_u32 s30, 0
    s_cbranch_scc0 Only_82
    s_cmp_eq_u32 s49, 2
    s_cbranch_scc1 W4_83
    s_cmp_ge_u32 s26, 192
    s_cbranch_scc1 W4_83
    v_bfe_u32 v9, v2, 2, 3
    v_mov_b32 v8, 28
    v_cmp_eq_u32 vcc, 6, v9
    s_nop 1
    v_cndmask_b32 v8, v8, 24, vcc
    v_cmp_eq_u32 vcc, 7, v9
    s_nop 1
    v_cndmask_b32 v8, v8, 0, vcc
    s_mov_b32 s50, 0
w2p_84:
    v_lshlrev_b32 v7, 7, v2
    v_and_b32 v7, 0xf80, v7
    s_lshl_b32 s41, s20, 12
    s_add_u32 s41, s41, 8192
    v_add_u32 v7, s41, v7
    buffer_load_dword v6, v7, s[96:99], 0 offen sc1
    s_waitcnt vmcnt(0)
    v_cmp_ge_u32 vcc, v6, v8
    s_nop 4
    s_mov_b32 s41, vcc_lo
    s_cmp_eq_u32 s41, -1
    s_cbranch_scc1 w2q_85
    s_add_u32 s50, s50, 1
    s_cmp_ge_u32 s50, 100000
    s_cbranch_scc1 w2q_85
    s_sleep 1
    s_branch w2p_84
w2q_85:
    s_lshl_b32 s40, s26, 14
    s_mov_b32 m0, 114688
    s_add_u32 s41, s40, 0
    buffer_load_dwordx4 v17, s[52:55], s41 offen sc1 lds
    s_mov_b32 m0, 115712
    s_add_u32 s41, s40, 1024
    buffer_load_dwordx4 v17, s[52:55], s41 offen sc1 lds
    s_mov_b32 m0, 116736
    s_add_u32 s41, s40, 2048
    buffer_load_dwordx4 v17, s[52:55], s41 offen sc1 lds
    s_mov_b32 m0, 117760
    s_add_u32 s41, s40, 3072
    buffer_load_dwordx4 v17, s[52:55], s41 offen sc1 lds
    s_mov_b32 m0, 118784
    s_add_u32 s41, s40, 4096
    buffer_load_dwordx4 v17, s[52:55], s41 offen sc1 lds
    s_mov_b32 m0, 119808
    s_add_u32 s41, s40, 5120
    buffer_load_dwordx4 v17, s[52:55], s41 offen sc1 lds
    s_mov_b32 m0, 120832
    s_add_u32 s41, s40, 6144
    buffer_load_dwordx4 v17, s[52:55], s41 offen sc1 lds
    s_mov_b32 m0, 121856
    s_add_u32 s41, s40, 7168
    buffer_load_dwordx4 v17, s[52:55], s41 offen sc1 lds
    s_mov_b32 m0, 122880
    s_add_u32 s41, s40, 8192
    buffer_load_dwordx4 v17, s[52:55], s41 offen sc1 lds
    s_mov_b32 m0, 123904
    s_add_u32 s41, s40, 9216
    buffer_load_dwordx4 v17, s[52:55], s41 offen sc1 lds
    s_mov_b32 m0, 124928
    s_add_u32 s41, s40, 10240
    buffer_load_dwordx4 v17, s[52:55], s41 offen sc1 lds
    s_mov_b32 m0, 125952
    s_add_u32 s41, s40, 11264
    buffer_load_dwordx4 v17, s[52:55], s41 offen sc1 lds
    s_mov_b32 m0, 126976
    s_add_u32 s41, s40, 12288
    buffer_load_dwordx4 v17, s[52:55], s41 offen sc1 lds
    s_mov_b32 m0, 128000
    s_add_u32 s41, s40, 13312
    buffer_load_dwordx4 v17, s[52:55], s41 offen sc1 lds
    s_mov_b32 m0, 129024
    s_add_u32 s41, s40, 14336
    buffer_load_dwordx4 v17, s[52:55], s41 offen sc1 lds
    s_mov_b32 m0, 130048
    s_add_u32 s41, s40, 15360
    buffer_load_dwordx4 v17, s[52:55], s41 offen sc1 lds
    s_waitcnt vmcnt(0)
W4_83:
    s_mov_b32 s49, 0
Only_82:
    s_barrier
    s_cmp_eq_u32 s26, s27
    s_cbranch_scc1 last_86
    s_barrier
    s_lshl_b32 s40, s26, 14
    s_lshl_b32 s41, s30, 12
    s_add_u32 s40, s40, s41
    ds_read_b128 v[20:23], v18 offset:0
    ds_read_b128 v[24:27], v18 offset:1024
    ds_read_b128 v[28:31], v18 offset:2048
    ds_read_b128 v[32:35], v18 offset:3072
    s_waitcnt lgkmcnt(3)
    s_add_u32 s41, s40, 0
    buffer_store_dwordx4 v[20:23], v17, s[56:59], s41 offen sc1
    s_waitcnt lgkmcnt(2)
    s_add_u32 s41, s40, 1024
    buffer_store_dwordx4 v[24:27], v17, s[56:59], s41 offen sc1
    s_waitcnt lgkmcnt(1)
    s_add_u32 s41, s40, 2048
    buffer_store_dwordx4 v[28:31], v17, s[56:59], s41 offen sc1
    s_waitcnt lgkmcnt(0)
    s_add_u32 s41, s40, 3072
    buffer_store_dwordx4 v[32:35], v17, s[56:59], s41 offen sc1
    s_waitcnt vmcnt(0)
    s_barrier
    s_cmp_eq_u32 s30, 0
    s_cbranch_scc0 Only_87
    v_mbcnt_lo_u32_b32 v4, -1, 0
    v_mbcnt_hi_u32_b32 v4, -1, v4
    v_lshlrev_b32 v4, 7, v4
    v_add_u32 v4, 1024, v4
    v_mov_b32 v5, 1
    s_mov_b64 exec, 255
    buffer_atomic_add v5, v4, s[96:99], 0 offen
    s_mov_b64 exec, -1
Only_87:
    s_mov_b32 s26, s27
    s_branch F_passL
last_86:
    s_lshr_b32 s40, s22, 1
    s_lshl_b32 s40, s40, 1
    s_add_u32 s40, s40, s25
    s_lshl_b32 s63, s40, 7
    s_cmp_eq_u32 s30, 0
    s_cbranch_scc0 hw_88
    s_add_u32 s40, s63, 2048
    v_mov_b32 v4, s40
    s_mov_b32 s41, 0
Poll_90:
    buffer_load_dword v5, v4, s[96:99], 0 offen sc1
    s_waitcnt vmcnt(0)
    v_readfirstlane_b32 s40, v5
    s_add_u32 s41, s41, 1
    s_cmp_ge_u32 s40, 14
    s_cbranch_scc1 PollD_91
    s_cmp_ge_u32 s41, 100000
    s_cbranch_scc1 PollD_91
    s_sleep 2
    s_branch Poll_90
PollD_91:
    v_mov_b32 v4, 98300
    v_mov_b32 v5, 1
    ds_write_b32 v4, v5
    s_branch hd_89
hw_88:
    v_mov_b32 v4, 98300
    s_mov_b32 s41, 0
sp_92:
    ds_read_b32 v5, v4
    s_waitcnt lgkmcnt(0)
    v_readfirstlane_b32 s40, v5
    s_add_u32 s41, s41, 1
    s_cmp_ge_u32 s40, 1
    s_cbranch_scc1 hd_89
    s_cmp_ge_u32 s41, 800000
    s_cbranch_scc1 hd_89
    s_sleep 1
    s_branch sp_92
hd_89:
    s_add_u32 s46, s42, s43
    s_add_u32 m0, s46, 0
    s_mov_b32 s47, s44
    buffer_load_dwordx4 v10, s[12:15], s47 offen sc1 lds
    s_add_u32 m0, s46, 4096
    s_add_u32 s47, s44, 229376
    buffer_load_dwordx4 v10, s[12:15], s47 offen sc1 lds
    s_add_u32 m0, s46, 8192
    s_add_u32 s47, s44, 458752
    buffer_load_dwordx4 v10, s[12:15], s47 offen sc1 lds
    s_add_u32 m0, s46, 12288
    s_add_u32 s47, s44, 688128
    buffer_load_dwordx4 v10, s[12:15], s47 offen sc1 lds
    s_add_u32 m0, s46, 16384
    s_mov_b32 s47, s45
    buffer_load_dwordx4 v11, s[16:19], s47 offen lds
    s_add_u32 m0, s46, 20480
    s_add_u32 s47, s45, 32768
    buffer_load_dwordx4 v11, s[16:19], s47 offen lds
    s_add_u32 m0, s46, 24576
    s_add_u32 s47, s45, 65536
    buffer_load_dwordx4 v11, s[16:19], s47 offen lds
    s_add_u32 m0, s46, 28672
    s_add_u32 s47, s45, 98304
    buffer_load_dwordx4 v11, s[16:19], s47 offen lds
    s_add_u32 s44, s44, 2048
    s_add_u32 s45, s45, 131072
    s_add_u32 s43, s43, 32768
    s_cmp_eq_u32 s43, 98304
    s_cselect_b32 s43, 0, s43
    s_add_u32 s46, s42, s43
    s_add_u32 m0, s46, 0
    s_mov_b32 s47, s44
    buffer_load_dwordx4 v10, s[12:15], s47 offen sc1 lds
    s_add_u32 m0, s46, 4096
    s_add_u32 s47, s44, 229376
    buffer_load_dwordx4 v10, s[12:15], s47 offen sc1 lds
    s_add_u32 m0, s46, 8192
    s_add_u32 s47, s44, 458752
    buffer_load_dwordx4 v10, s[12:15], s47 offen sc1 lds
    s_add_u32 m0, s46, 12288
    s_add_u32 s47, s44, 688128
    buffer_load_dwordx4 v10, s[12:15], s47 offen sc1 lds
    s_add_u32 m0, s46, 16384
    s_mov_b32 s47, s45
    buffer_load_dwordx4 v11, s[16:19], s47 offen lds
    s_add_u32 m0, s46, 20480
    s_add_u32 s47, s45, 32768
    buffer_load_dwordx4 v11, s[16:19], s47 offen lds
    s_add_u32 m0, s46, 24576
    s_add_u32 s47, s45, 65536
    buffer_load_dwordx4 v11, s[16:19], s47 offen lds
    s_add_u32 m0, s46, 28672
    s_add_u32 s47, s45, 98304
    buffer_load_dwordx4 v11, s[16:19], s47 offen lds
    s_add_u32 s44, s44, 2048
    s_add_u32 s45, s45, 131072
    s_add_u32 s43, s43, 32768
    s_cmp_eq_u32 s43, 98304
    s_cselect_b32 s43, 0, s43
    s_barrier
    s_lshl_b32 s40, s27, 14
    s_lshl_b32 s41, s30, 12
    s_add_u32 s40, s40, s41
    ds_read_b128 v[20:23], v18 offset:0
    ds_read_b128 v[24:27], v18 offset:1024
    ds_read_b128 v[28:31], v18 offset:2048
    ds_read_b128 v[32:35], v18 offset:3072
    s_waitcnt lgkmcnt(3)
    s_add_u32 s41, s40, 0
    buffer_store_dwordx4 v[20:23], v17, s[56:59], s41 offen sc1
    s_waitcnt lgkmcnt(2)
    s_add_u32 s41, s40, 1024
    buffer_store_dwordx4 v[24:27], v17, s[56:59], s41 offen sc1
    s_waitcnt lgkmcnt(1)
    s_add_u32 s41, s40, 2048
    buffer_store_dwordx4 v[28:31], v17, s[56:59], s41 offen sc1
    s_waitcnt lgkmcnt(0)
    s_add_u32 s41, s40, 3072
    buffer_store_dwordx4 v[32:35], v17, s[56:59], s41 offen sc1
    s_waitcnt vmcnt(12)
    s_barrier
    s_add_u32 s46, s42, s43
    s_add_u32 m0, s46, 0
    s_mov_b32 s47, s44
    buffer_load_dwordx4 v10, s[12:15], s47 offen sc1 lds
    s_add_u32 m0, s46, 4096
    s_add_u32 s47, s44, 229376
    buffer_load_dwordx4 v10, s[12:15], s47 offen sc1 lds
    s_add_u32 m0, s46, 8192
    s_add_u32 s47, s44, 458752
    buffer_load_dwordx4 v10, s[12:15], s47 offen sc1 lds
    s_add_u32 m0, s46, 12288
    s_add_u32 s47, s44, 688128
    buffer_load_dwordx4 v10, s[12:15], s47 offen sc1 lds
    s_add_u32 m0, s46, 16384
    s_mov_b32 s47, s45
    buffer_load_dwordx4 v11, s[16:19], s47 offen lds
    s_add_u32 m0, s46, 20480
    s_add_u32 s47, s45, 32768
    buffer_load_dwordx4 v11, s[16:19], s47 offen lds
    s_add_u32 m0, s46, 24576
    s_add_u32 s47, s45, 65536
    buffer_load_dwordx4 v11, s[16:19], s47 offen lds
    s_add_u32 m0, s46, 28672
    s_add_u32 s47, s45, 98304
    buffer_load_dwordx4 v11, s[16:19], s47 offen lds
    s_add_u32 s44, s44, 2048
    s_add_u32 s45, s45, 131072
    s_add_u32 s43, s43, 32768
    s_cmp_eq_u32 s43, 98304
    s_cselect_b32 s43, 0, s43
    s_waitcnt vmcnt(8)
    s_barrier
    s_add_u32 s46, s42, s43
    s_add_u32 m0, s46, 0
    s_mov_b32 s47, s44
    buffer_load_dwordx4 v10, s[12:15], s47 offen sc1 lds
    s_add_u32 m0, s46, 4096
    s_add_u32 s47, s44, 229376
    buffer_load_dwordx4 v10, s[12:15], s47 offen sc1 lds
    s_add_u32 m0, s46, 8192
    s_add_u32 s47, s44, 458752
    buffer_load_dwordx4 v10, s[12:15], s47 offen sc1 lds
    s_add_u32 m0, s46, 12288
    s_add_u32 s47, s44, 688128
    buffer_load_dwordx4 v10, s[12:15], s47 offen sc1 lds
    s_add_u32 m0, s46, 16384
    s_mov_b32 s47, s45
    buffer_load_dwordx4 v11, s[16:19], s47 offen lds
    s_add_u32 m0, s46, 20480
    s_add_u32 s47, s45, 32768
    buffer_load_dwordx4 v11, s[16:19], s47 offen lds
    s_add_u32 m0, s46, 24576
    s_add_u32 s47, s45, 65536
    buffer_load_dwordx4 v11, s[16:19], s47 offen lds
    s_add_u32 m0, s46, 28672
    s_add_u32 s47, s45, 98304
    buffer_load_dwordx4 v11, s[16:19], s47 offen lds
    s_add_u32 s44, s44, 2048
    s_add_u32 s45, s45, 131072
    s_add_u32 s43, s43, 32768
    s_cmp_eq_u32 s43, 98304
    s_cselect_b32 s43, 0, s43
    s_cmp_eq_u32 s30, 0
    s_cbranch_scc0 Only_93
    v_mbcnt_lo_u32_b32 v4, -1, 0
    v_mbcnt_hi_u32_b32 v4, -1, v4
    v_lshlrev_b32 v4, 7, v4
    v_add_u32 v4, 1024, v4
    v_mov_b32 v5, 1
    s_mov_b64 exec, 255
    buffer_atomic_add v5, v4, s[96:99], 0 offen
    s_mov_b64 exec, -1
Only_93:
    s_mov_b32 s48, 2
Lld_94:
    s_waitcnt vmcnt(8)
    s_barrier
    s_add_u32 s46, s42, s43
    s_add_u32 m0, s46, 0
    s_mov_b32 s47, s44
    buffer_load_dwordx4 v10, s[12:15], s47 offen sc1 lds
    s_add_u32 m0, s46, 4096
    s_add_u32 s47, s44, 229376
    buffer_load_dwordx4 v10, s[12:15], s47 offen sc1 lds
    s_add_u32 m0, s46, 8192
    s_add_u32 s47, s44, 458752
    buffer_load_dwordx4 v10, s[12:15], s47 offen sc1 lds
    s_add_u32 m0, s46, 12288
    s_add_u32 s47, s44, 688128
    buffer_load_dwordx4 v10, s[12:15], s47 offen sc1 lds
    s_add_u32 m0, s46, 16384
    s_mov_b32 s47, s45
    buffer_load_dwordx4 v11, s[16:19], s47 offen lds
    s_add_u32 m0, s46, 20480
    s_add_u32 s47, s45, 32768
    buffer_load_dwordx4 v11, s[16:19], s47 offen lds
    s_add_u32 m0, s46, 24576
    s_add_u32 s47, s45, 65536
    buffer_load_dwordx4 v11, s[16:19], s47 offen lds
    s_add_u32 m0, s46, 28672
    s_add_u32 s47, s45, 98304
    buffer_load_dwordx4 v11, s[16:19], s47 offen lds
    s_add_u32 s44, s44, 2048
    s_add_u32 s45, s45, 131072
    s_add_u32 s43, s43, 32768
    s_cmp_eq_u32 s43, 98304
    s_cselect_b32 s43, 0, s43
    s_add_u32 s48, s48, 1
    s_cmp_lt_u32 s48, 25
    s_cbranch_scc1 Lld_94
    s_waitcnt vmcnt(8)
    s_barrier
    s_cmp_eq_u32 s30, 0
    s_cbranch_scc0 Only_95
    s_add_u32 s40, s62, 1024
    v_mov_b32 v4, s40
    buffer_load_dword v6, v4, s[96:99], 0 offen sc1
Only_95:
    s_add_u32 s46, s42, s43
    s_add_u32 m0, s46, 0
    s_mov_b32 s47, s44
    buffer_load_dwordx4 v10, s[12:15], s47 offen sc1 lds
    s_add_u32 m0, s46, 4096
    s_add_u32 s47, s44, 229376
    buffer_load_dwordx4 v10, s[12:15], s47 offen sc1 lds
    s_add_u32 m0, s46, 8192
    s_add_u32 s47, s44, 458752
    buffer_load_dwordx4 v10, s[12:15], s47 offen sc1 lds
    s_add_u32 m0, s46, 12288
    s_add_u32 s47, s44, 688128
    buffer_load_dwordx4 v10, s[12:15], s47 offen sc1 lds
    s_add_u32 m0, s46, 16384
    s_mov_b32 s47, s45
    buffer_load_dwordx4 v11, s[16:19], s47 offen lds
    s_add_u32 m0, s46, 20480
    s_add_u32 s47, s45, 32768
    buffer_load_dwordx4 v11, s[16:19], s47 offen lds
    s_add_u32 m0, s46, 24576
    s_add_u32 s47, s45, 65536
    buffer_load_dwordx4 v11, s[16:19], s47 offen lds
    s_add_u32 m0, s46, 28672
    s_add_u32 s47, s45, 98304
    buffer_load_dwordx4 v11, s[16:19], s47 offen lds
    s_add_u32 s44, s44, 2048
    s_add_u32 s45, s45, 131072
    s_add_u32 s43, s43, 32768
    s_cmp_eq_u32 s43, 98304
    s_cselect_b32 s43, 0, s43
    s_waitcnt vmcnt(8)
    s_cmp_eq_u32 s30, 0
    s_cbranch_scc0 Only_96
    v_readfirstlane_b32 s40, v6
    s_cmp_ge_u32 s40, 257
    s_cbranch_scc1 p3_97
    s_add_u32 s40, s62, 1024
    v_mov_b32 v4, s40
    s_mov_b32 s41, 0
Poll_98:
    buffer_load_dword v5, v4, s[96:99], 0 offen sc1
    s_waitcnt vmcnt(0)
    v_readfirstlane_b32 s40, v5
    s_add_u32 s41, s41, 1
    s_cmp_ge_u32 s40, 257
    s_cbranch_scc1 PollD_99
    s_cmp_ge_u32 s41, 100000
    s_cbranch_scc1 PollD_99
    s_sleep 2
    s_branch Poll_98
PollD_99:
p3_97:
Only_96:
    s_barrier
    s_lshl_b32 s60, s22, 4
    s_lshr_b32 s40, s20, 1
    s_lshl_b32 s40, s40, 2
    s_add_u32 s60, s60, s40
    s_lshr_b32 s40, s21, 3
    s_add_u32 s60, s60, s40
    v_and_b32 v4, 31, v2
    v_lshrrev_b32 v5, 5, v2
    s_lshl_b32 s46, s60, 6
    s_cmp_eq_u32 s30, 0
    s_cbranch_scc1 V0_100
    s_sub_u32 s40, s30, 1
    s_lshl_b32 s40, s40, 20
    s_add_u32 s46, s46, s40
    v_lshrrev_b32 v6, 4, v4
    v_lshlrev_b32 v6, 14, v6
    v_and_b32 v7, 15, v4
    v_lshl_add_u32 v6, v7, 2, v6
    v_lshl_add_u32 v20, v5, 17, v6
    s_add_u32 s47, s46, 0
    buffer_load_dword v32, v20, s[56:59], s47 offen sc1
    s_add_u32 s47, s46, 32768
    buffer_load_dword v33, v20, s[56:59], s47 offen sc1
    s_add_u32 s47, s46, 65536
    buffer_load_dword v34, v20, s[56:59], s47 offen sc1
    s_add_u32 s47, s46, 98304
    buffer_load_dword v35, v20, s[56:59], s47 offen sc1
    s_add_u32 s47, s46, 262144
    buffer_load_dword v36, v20, s[56:59], s47 offen sc1
    s_add_u32 s47, s46, 294912
    buffer_load_dword v37, v20, s[56:59], s47 offen sc1
    s_add_u32 s47, s46, 327680
    buffer_load_dword v38, v20, s[56:59], s47 offen sc1
    s_add_u32 s47, s46, 360448
    buffer_load_dword v39, v20, s[56:59], s47 offen sc1
    s_add_u32 s47, s46, 524288
    buffer_load_dword v40, v20, s[56:59], s47 offen sc1
    s_add_u32 s47, s46, 557056
    buffer_load_dword v41, v20, s[56:59], s47 offen sc1
    s_add_u32 s47, s46, 589824
    buffer_load_dword v42, v20, s[56:59], s47 offen sc1
    s_add_u32 s47, s46, 622592
    buffer_load_dword v43, v20, s[56:59], s47 offen sc1
    s_add_u32 s47, s46, 786432
    buffer_load_dword v44, v20, s[56:59], s47 offen sc1
    s_add_u32 s47, s46, 819200
    buffer_load_dword v45, v20, s[56:59], s47 offen sc1
    s_add_u32 s47, s46, 851968
    buffer_load_dword v46, v20, s[56:59], s47 offen sc1
    s_add_u32 s47, s46, 884736
    buffer_load_dword v47, v20, s[56:59], s47 offen sc1
    s_branch V1_101
V0_100:
    s_add_u32 s46, s46, 3145728
    v_lshrrev_b32 v6, 3, v4
    v_lshlrev_b32 v6, 14, v6
    v_and_b32 v7, 7, v4
    v_lshl_add_u32 v6, v7, 2, v6
    v_lshl_add_u32 v20, v5, 18, v6
    v_sub_u32 v6, 32, v4
    v_lshrrev_b32 v7, 3, v6
    v_lshlrev_b32 v7, 14, v7
    v_and_b32 v6, 7, v6
    v_add_u32 v6, 8, v6
    v_lshl_add_u32 v6, v6, 2, v7
    v_xor_b32 v7, 1, v5
    v_lshl_add_u32 v21, v7, 18, v6
    s_add_u32 s47, s46, 0
    buffer_load_dword v32, v20, s[56:59], s47 offen sc1
    s_add_u32 s47, s46, 65536
    buffer_load_dword v33, v20, s[56:59], s47 offen sc1
    s_add_u32 s47, s46, 131072
    buffer_load_dword v34, v20, s[56:59], s47 offen sc1
    s_add_u32 s47, s46, 196608
    buffer_load_dword v35, v20, s[56:59], s47 offen sc1
    s_add_u32 s47, s46, 524288
    buffer_load_dword v36, v20, s[56:59], s47 offen sc1
    s_add_u32 s47, s46, 589824
    buffer_load_dword v37, v20, s[56:59], s47 offen sc1
    s_add_u32 s47, s46, 655360
    buffer_load_dword v38, v20, s[56:59], s47 offen sc1
    s_add_u32 s47, s46, 720896
    buffer_load_dword v39, v20, s[56:59], s47 offen sc1
    s_add_u32 s47, s46, 720896
    buffer_load_dword v40, v21, s[56:59], s47 offen sc1
    s_add_u32 s47, s46, 655360
    buffer_load_dword v41, v21, s[56:59], s47 offen sc1
    s_add_u32 s47, s46, 589824
    buffer_load_dword v42, v21, s[56:59], s47 offen sc1
    s_add_u32 s47, s46, 524288
    buffer_load_dword v43, v21, s[56:59], s47 offen sc1
    s_add_u32 s47, s46, 196608
    buffer_load_dword v44, v21, s[56:59], s47 offen sc1
    s_add_u32 s47, s46, 131072
    buffer_load_dword v45, v21, s[56:59], s47 offen sc1
    s_add_u32 s47, s46, 65536
    buffer_load_dword v46, v21, s[56:59], s47 offen sc1
    s_add_u32 s47, s46, 0
    buffer_load_dword v47, v21, s[56:59], s47 offen sc1
V1_101:
    s_waitcnt vmcnt(16)
    s_barrier
    s_waitcnt vmcnt(0)
    v_mfma_f32_32x32x16_bf16 v[144:159], v[32:35], v[80:83], 0
    v_mfma_f32_32x32x16_bf16 v[160:175], v[32:35], v[96:99], 0
    v_mfma_f32_32x32x16_bf16 v[144:159], v[36:39], v[84:87], v[144:159]
    v_mfma_f32_32x32x16_bf16 v[160:175], v[36:39], v[100:103], v[160:175]
    v_mfma_f32_32x32x16_bf16 v[144:159], v[40:43], v[88:91], v[144:159]
    v_mfma_f32_32x32x16_bf16 v[160:175], v[40:43], v[104:107], v[160:175]
    v_mfma_f32_32x32x16_bf16 v[144:159], v[44:47], v[92:95], v[144:159]
    v_mfma_f32_32x32x16_bf16 v[160:175], v[44:47], v[108:111], v[160:175]
    s_nop 7
    s_nop 3
    v_pk_mul_f32 v[4:5], v[144:145], v[112:113]
    v_pk_mul_f32 v[6:7], v[160:161], v[112:113]
    v_pk_fma_f32 v[4:5], v[160:161], v[128:129], v[4:5] neg_lo:[1,0,0] neg_hi:[1,0,0]
    v_pk_fma_f32 v[6:7], v[144:145], v[128:129], v[6:7]
    v_cvt_pk_bf16_f32 v176, v4, v6
    v_cvt_pk_bf16_f32 v177, v5, v7
    v_pk_mul_f32 v[8:9], v[146:147], v[114:115]
    v_pk_mul_f32 v[10:11], v[162:163], v[114:115]
    v_pk_fma_f32 v[8:9], v[162:163], v[130:131], v[8:9] neg_lo:[1,0,0] neg_hi:[1,0,0]
    v_pk_fma_f32 v[10:11], v[146:147], v[130:131], v[10:11]
    v_cvt_pk_bf16_f32 v178, v8, v10
    v_cvt_pk_bf16_f32 v179, v9, v11
    v_pk_mul_f32 v[4:5], v[148:149], v[116:117]
    v_pk_mul_f32 v[6:7], v[164:165], v[116:117]
    v_pk_fma_f32 v[4:5], v[164:165], v[132:133], v[4:5] neg_lo:[1,0,0] neg_hi:[1,0,0]
    v_pk_fma_f32 v[6:7], v[148:149], v[132:133], v[6:7]
    v_cvt_pk_bf16_f32 v180, v4, v6
    v_cvt_pk_bf16_f32 v181, v5, v7
    v_pk_mul_f32 v[8:9], v[150:151], v[118:119]
    v_pk_mul_f32 v[10:11], v[166:167], v[118:119]
    v_pk_fma_f32 v[8:9], v[166:167], v[134:135], v[8:9] neg_lo:[1,0,0] neg_hi:[1,0,0]
    v_pk_fma_f32 v[10:11], v[150:151], v[134:135], v[10:11]
    v_cvt_pk_bf16_f32 v182, v8, v10
    v_cvt_pk_bf16_f32 v183, v9, v11
    v_pk_mul_f32 v[4:5], v[152:153], v[120:121]
    v_pk_mul_f32 v[6:7], v[168:169], v[120:121]
    v_pk_fma_f32 v[4:5], v[168:169], v[136:137], v[4:5] neg_lo:[1,0,0] neg_hi:[1,0,0]
    v_pk_fma_f32 v[6:7], v[152:153], v[136:137], v[6:7]
    v_cvt_pk_bf16_f32 v184, v4, v6
    v_cvt_pk_bf16_f32 v185, v5, v7
    v_pk_mul_f32 v[8:9], v[154:155], v[122:123]
    v_pk_mul_f32 v[10:11], v[170:171], v[122:123]
    v_pk_fma_f32 v[8:9], v[170:171], v[138:139], v[8:9] neg_lo:[1,0,0] neg_hi:[1,0,0]
    v_pk_fma_f32 v[10:11], v[154:155], v[138:139], v[10:11]
    v_cvt_pk_bf16_f32 v186, v8, v10
    v_cvt_pk_bf16_f32 v187, v9, v11
    v_pk_mul_f32 v[4:5], v[156:157], v[124:125]
    v_pk_mul_f32 v[6:7], v[172:173], v[124:125]
    v_pk_fma_f32 v[4:5], v[172:173], v[140:141], v[4:5] neg_lo:[1,0,0] neg_hi:[1,0,0]
    v_pk_fma_f32 v[6:7], v[156:157], v[140:141], v[6:7]
    v_cvt_pk_bf16_f32 v188, v4, v6
    v_cvt_pk_bf16_f32 v189, v5, v7
    v_pk_mul_f32 v[8:9], v[158:159], v[126:127]
    v_pk_mul_f32 v[10:11], v[174:175], v[126:127]
    v_pk_fma_f32 v[8:9], v[174:175], v[142:143], v[8:9] neg_lo:[1,0,0] neg_hi:[1,0,0]
    v_pk_fma_f32 v[10:11], v[158:159], v[142:143], v[10:11]
    v_cvt_pk_bf16_f32 v190, v8, v10
    v_cvt_pk_bf16_f32 v191, v9, v11
    s_nop 1
    v_mfma_f32_32x32x16_bf16 v[144:159], v[80:83], v[176:179], 0
    v_mfma_f32_32x32x16_bf16 v[160:175], v[96:99], v[176:179], 0
    v_mfma_f32_32x32x16_bf16 v[144:159], v[84:87], v[180:183], v[144:159]
    v_mfma_f32_32x32x16_bf16 v[160:175], v[100:103], v[180:183], v[160:175]
    v_mfma_f32_32x32x16_bf16 v[144:159], v[88:91], v[184:187], v[144:159]
    v_mfma_f32_32x32x16_bf16 v[160:175], v[104:107], v[184:187], v[160:175]
    v_mfma_f32_32x32x16_bf16 v[144:159], v[92:95], v[188:191], v[144:159]
    v_mfma_f32_32x32x16_bf16 v[160:175], v[108:111], v[188:191], v[160:175]
    v_and_b32 v4, 31, v2
    v_lshrrev_b32 v5, 5, v2
    v_lshl_add_u32 v4, v5, 7, v4
    v_lshlrev_b32 v4, 2, v4
    s_lshl_b32 s40, s30, 12
    s_add_u32 s40, s40, 131072
    v_add_u32 v4, s40, v4
    s_nop 7
    v_cvt_pk_bf16_f32 v176, v144, v160
    v_cvt_pk_bf16_f32 v177, v145, v161
    v_cvt_pk_bf16_f32 v178, v146, v162
    v_cvt_pk_bf16_f32 v179, v147, v163
    v_cvt_pk_bf16_f32 v180, v148, v164
    v_cvt_pk_bf16_f32 v181, v149, v165
    v_cvt_pk_bf16_f32 v182, v150, v166
    v_cvt_pk_bf16_f32 v183, v151, v167
    v_cvt_pk_bf16_f32 v184, v152, v168
    v_cvt_pk_bf16_f32 v185, v153, v169
    v_cvt_pk_bf16_f32 v186, v154, v170
    v_cvt_pk_bf16_f32 v187, v155, v171
    v_cvt_pk_bf16_f32 v188, v156, v172
    v_cvt_pk_bf16_f32 v189, v157, v173
    v_cvt_pk_bf16_f32 v190, v158, v174
    v_cvt_pk_bf16_f32 v191, v159, v175
    ds_write_b32 v4, v176 offset:0
    ds_write_b32 v4, v177 offset:128
    ds_write_b32 v4, v178 offset:256
    ds_write_b32 v4, v179 offset:384
    ds_write_b32 v4, v180 offset:1024
    ds_write_b32 v4, v181 offset:1152
    ds_write_b32 v4, v182 offset:1280
    ds_write_b32 v4, v183 offset:1408
    ds_write_b32 v4, v184 offset:2048
    ds_write_b32 v4, v185 offset:2176
    ds_write_b32 v4, v186 offset:2304
    ds_write_b32 v4, v187 offset:2432
    ds_write_b32 v4, v188 offset:3072
    ds_write_b32 v4, v189 offset:3200
    ds_write_b32 v4, v190 offset:3328
    ds_write_b32 v4, v191 offset:3456
    s_branch F_final
F_p2cons:
    v_and_b32 v20, 15, v2
    v_lshrrev_b32 v21, 4, v2
    v_lshlrev_b32 v21, 2, v21
    s_mov_b32 s40, 1031798784
    v_add_u32 v23, 0, v21
    v_mul_u32_u24 v24, v23, v20
    v_and_b32 v24, 15, v24
    v_cvt_f32_u32 v24, v24
    v_mul_f32 v24, s40, v24
    v_cos_f32 v25, v24
    v_sin_f32 v26, v24
    s_nop 0
    v_cvt_pk_bf16_f32 v28, v25, v26
    v_cvt_pk_bf16_f32 v32, -v26, v25
    v_cvt_pk_bf16_f32 v36, v25, -v26
    v_cvt_pk_bf16_f32 v40, v26, v25
    v_add_u32 v23, 1, v21
    v_mul_u32_u24 v24, v23, v20
    v_and_b32 v24, 15, v24
    v_cvt_f32_u32 v24, v24
    v_mul_f32 v24, s40, v24
    v_cos_f32 v25, v24
    v_sin_f32 v26, v24
    s_nop 0
    v_cvt_pk_bf16_f32 v29, v25, v26
    v_cvt_pk_bf16_f32 v33, -v26, v25
    v_cvt_pk_bf16_f32 v37, v25, -v26
    v_cvt_pk_bf16_f32 v41, v26, v25
    v_add_u32 v23, 2, v21
    v_mul_u32_u24 v24, v23, v20
    v_and_b32 v24, 15, v24
    v_cvt_f32_u32 v24, v24
    v_mul_f32 v24, s40, v24
    v_cos_f32 v25, v24
    v_sin_f32 v26, v24
    s_nop 0
    v_cvt_pk_bf16_f32 v30, v25, v26
    v_cvt_pk_bf16_f32 v34, -v26, v25
    v_cvt_pk_bf16_f32 v38, v25, -v26
    v_cvt_pk_bf16_f32 v42, v26, v25
    v_add_u32 v23, 3, v21
    v_mul_u32_u24 v24, v23, v20
    v_and_b32 v24, 15, v24
    v_cvt_f32_u32 v24, v24
    v_mul_f32 v24, s40, v24
    v_cos_f32 v25, v24
    v_sin_f32 v26, v24
    s_nop 0
    v_cvt_pk_bf16_f32 v31, v25, v26
    v_cvt_pk_bf16_f32 v35, -v26, v25
    v_cvt_pk_bf16_f32 v39, v25, -v26
    v_cvt_pk_bf16_f32 v43, v26, v25
    s_cmp_ge_u32 s2, 192
    s_cbranch_scc1 P2s0_102
    s_lshr_b32 s46, s2, 6
    s_add_u32 s46, s46, 1
    v_and_b32 v20, 15, v2
    v_lshrrev_b32 v21, 4, v2
    v_lshlrev_b32 v21, 2, v21
    v_lshlrev_b32 v22, 3, v20
    v_add_u32 v22, s46, v22
    s_mov_b32 s40, 1006632960
    s_mov_b32 s41, 973078528
    v_add_u32 v23, 0, v21
    v_mul_u32_u24 v24, v23, v22
    v_cvt_f32_u32 v25, v24
    v_mul_f32 v52, s41, v25
    v_and_b32 v24, 127, v24
    v_cvt_f32_u32 v24, v24
    v_mul_f32 v24, s40, v24
    v_cos_f32 v25, v24
    v_sin_f32 v26, v24
    v_sin_f32 v56, v52
    v_cos_f32 v52, v52
    v_cvt_pk_bf16_f32 v44, v25, v26
    v_cvt_pk_bf16_f32 v48, -v26, v25
    v_lshlrev_b32 v24, 3, v23
    v_add_u32 v24, s46, v24
    v_mul_u32_u24 v24, v24, v20
    v_cvt_f32_u32 v25, v24
    v_mul_f32 v60, s41, v25
    v_and_b32 v24, 127, v24
    v_cvt_f32_u32 v24, v24
    v_mul_f32 v24, s40, v24
    v_cos_f32 v25, v24
    v_sin_f32 v26, v24
    v_sin_f32 v64, v60
    v_cos_f32 v60, v60
    v_cvt_pk_bf16_f32 v68, v25, -v26
    v_cvt_pk_bf16_f32 v72, v26, v25
    v_add_u32 v23, 1, v21
    v_mul_u32_u24 v24, v23, v22
    v_cvt_f32_u32 v25, v24
    v_mul_f32 v53, s41, v25
    v_and_b32 v24, 127, v24
    v_cvt_f32_u32 v24, v24
    v_mul_f32 v24, s40, v24
    v_cos_f32 v25, v24
    v_sin_f32 v26, v24
    v_sin_f32 v57, v53
    v_cos_f32 v53, v53
    v_cvt_pk_bf16_f32 v45, v25, v26
    v_cvt_pk_bf16_f32 v49, -v26, v25
    v_lshlrev_b32 v24, 3, v23
    v_add_u32 v24, s46, v24
    v_mul_u32_u24 v24, v24, v20
    v_cvt_f32_u32 v25, v24
    v_mul_f32 v61, s41, v25
    v_and_b32 v24, 127, v24
    v_cvt_f32_u32 v24, v24
    v_mul_f32 v24, s40, v24
    v_cos_f32 v25, v24
    v_sin_f32 v26, v24
    v_sin_f32 v65, v61
    v_cos_f32 v61, v61
    v_cvt_pk_bf16_f32 v69, v25, -v26
    v_cvt_pk_bf16_f32 v73, v26, v25
    v_add_u32 v23, 2, v21
    v_mul_u32_u24 v24, v23, v22
    v_cvt_f32_u32 v25, v24
    v_mul_f32 v54, s41, v25
    v_and_b32 v24, 127, v24
    v_cvt_f32_u32 v24, v24
    v_mul_f32 v24, s40, v24
    v_cos_f32 v25, v24
    v_sin_f32 v26, v24
    v_sin_f32 v58, v54
    v_cos_f32 v54, v54
    v_cvt_pk_bf16_f32 v46, v25, v26
    v_cvt_pk_bf16_f32 v50, -v26, v25
    v_lshlrev_b32 v24, 3, v23
    v_add_u32 v24, s46, v24
    v_mul_u32_u24 v24, v24, v20
    v_cvt_f32_u32 v25, v24
    v_mul_f32 v62, s41, v25
    v_and_b32 v24, 127, v24
    v_cvt_f32_u32 v24, v24
    v_mul_f32 v24, s40, v24
    v_cos_f32 v25, v24
    v_sin_f32 v26, v24
    v_sin_f32 v66, v62
    v_cos_f32 v62, v62
    v_cvt_pk_bf16_f32 v70, v25, -v26
    v_cvt_pk_bf16_f32 v74, v26, v25
    v_add_u32 v23, 3, v21
    v_mul_u32_u24 v24, v23, v22
    v_cvt_f32_u32 v25, v24
    v_mul_f32 v55, s41, v25
    v_and_b32 v24, 127, v24
    v_cvt_f32_u32 v24, v24
    v_mul_f32 v24, s40, v24
    v_cos_f32 v25, v24
    v_sin_f32 v26, v24
    v_sin_f32 v59, v55
    v_cos_f32 v55, v55
    v_cvt_pk_bf16_f32 v47, v25, v26
    v_cvt_pk_bf16_f32 v51, -v26, v25
    v_lshlrev_b32 v24, 3, v23
    v_add_u32 v24, s46, v24
    v_mul_u32_u24 v24, v24, v20
    v_cvt_f32_u32 v25, v24
    v_mul_f32 v63, s41, v25
    v_and_b32 v24, 127, v24
    v_cvt_f32_u32 v24, v24
    v_mul_f32 v24, s40, v24
    v_cos_f32 v25, v24
    v_sin_f32 v26, v24
    v_sin_f32 v67, v63
    v_cos_f32 v63, v63
    v_cvt_pk_bf16_f32 v71, v25, -v26
    v_cvt_pk_bf16_f32 v75, v26, v25
    v_and_b32 v20, 15, v2
    v_lshrrev_b32 v21, 4, v2
    v_lshl_add_u32 v21, v21, 6, v20
    v_lshlrev_b32 v21, 6, v21
    v_lshrrev_b32 v20, 2, v20
    v_xor_b32 v20, s31, v20
    v_lshl_add_u32 v228, v20, 4, v21
    v_add_u32 v228, 98304, v228
    s_cmp_eq_u32 s34, 1
    s_cbranch_scc0 X0s_104
    s_waitcnt vmcnt(0)
    s_barrier
X0s_104:
    s_barrier
    ds_read_b128 v[108:111], v228 offset:0
    ds_read_b128 v[112:115], v228 offset:1024
    ds_read_b128 v[116:119], v228 offset:2048
    ds_read_b128 v[120:123], v228 offset:3072
    s_waitcnt lgkmcnt(0)
    v_mov_b32 v140, v108
    v_mov_b32 v141, v112
    v_mov_b32 v142, v116
    v_mov_b32 v143, v120
    v_mov_b32 v144, v109
    v_mov_b32 v145, v113
    v_mov_b32 v146, v117
    v_mov_b32 v147, v121
    v_mov_b32 v148, v110
    v_mov_b32 v149, v114
    v_mov_b32 v150, v118
    v_mov_b32 v151, v122
    v_mov_b32 v152, v111
    v_mov_b32 v153, v115
    v_mov_b32 v154, v119
    v_mov_b32 v155, v123
    s_nop 1
    v_mfma_f32_16x16x32_bf16 v[156:159], v[140:143], v[44:47], 0
    v_mfma_f32_16x16x32_bf16 v[172:175], v[140:143], v[48:51], 0
    v_mfma_f32_16x16x32_bf16 v[160:163], v[144:147], v[44:47], 0
    v_mfma_f32_16x16x32_bf16 v[176:179], v[144:147], v[48:51], 0
    v_mfma_f32_16x16x32_bf16 v[164:167], v[148:151], v[44:47], 0
    v_mfma_f32_16x16x32_bf16 v[180:183], v[148:151], v[48:51], 0
    v_mfma_f32_16x16x32_bf16 v[168:171], v[152:155], v[44:47], 0
    v_mfma_f32_16x16x32_bf16 v[184:187], v[152:155], v[48:51], 0
    s_nop 7
    v_pk_mul_f32 v[220:221], v[156:157], v[52:53]
    v_pk_mul_f32 v[222:223], v[172:173], v[52:53]
    v_pk_fma_f32 v[220:221], v[172:173], v[56:57], v[220:221]
    v_pk_fma_f32 v[222:223], v[156:157], v[56:57], v[222:223] neg_lo:[1,0,0] neg_hi:[1,0,0]
    v_pk_mul_f32 v[224:225], v[158:159], v[54:55]
    v_pk_mul_f32 v[226:227], v[174:175], v[54:55]
    v_pk_fma_f32 v[224:225], v[174:175], v[58:59], v[224:225]
    v_pk_fma_f32 v[226:227], v[158:159], v[58:59], v[226:227] neg_lo:[1,0,0] neg_hi:[1,0,0]
    v_cvt_pk_bf16_f32 v140, v220, v222
    v_cvt_pk_bf16_f32 v141, v221, v223
    v_cvt_pk_bf16_f32 v142, v224, v226
    v_cvt_pk_bf16_f32 v143, v225, v227
    v_pk_mul_f32 v[220:221], v[160:161], v[52:53]
    v_pk_mul_f32 v[222:223], v[176:177], v[52:53]
    v_pk_fma_f32 v[220:221], v[176:177], v[56:57], v[220:221]
    v_pk_fma_f32 v[222:223], v[160:161], v[56:57], v[222:223] neg_lo:[1,0,0] neg_hi:[1,0,0]
    v_pk_mul_f32 v[224:225], v[162:163], v[54:55]
    v_pk_mul_f32 v[226:227], v[178:179], v[54:55]
    v_pk_fma_f32 v[224:225], v[178:179], v[58:59], v[224:225]
    v_pk_fma_f32 v[226:227], v[162:163], v[58:59], v[226:227] neg_lo:[1,0,0] neg_hi:[1,0,0]
    v_cvt_pk_bf16_f32 v144, v220, v222
    v_cvt_pk_bf16_f32 v145, v221, v223
    v_cvt_pk_bf16_f32 v146, v224, v226
    v_cvt_pk_bf16_f32 v147, v225, v227
    v_pk_mul_f32 v[220:221], v[164:165], v[52:53]
    v_pk_mul_f32 v[222:223], v[180:181], v[52:53]
    v_pk_fma_f32 v[220:221], v[180:181], v[56:57], v[220:221]
    v_pk_fma_f32 v[222:223], v[164:165], v[56:57], v[222:223] neg_lo:[1,0,0] neg_hi:[1,0,0]
    v_pk_mul_f32 v[224:225], v[166:167], v[54:55]
    v_pk_mul_f32 v[226:227], v[182:183], v[54:55]
    v_pk_fma_f32 v[224:225], v[182:183], v[58:59], v[224:225]
    v_pk_fma_f32 v[226:227], v[166:167], v[58:59], v[226:227] neg_lo:[1,0,0] neg_hi:[1,0,0]
    v_cvt_pk_bf16_f32 v148, v220, v222
    v_cvt_pk_bf16_f32 v149, v221, v223
    v_cvt_pk_bf16_f32 v150, v224, v226
    v_cvt_pk_bf16_f32 v151, v225, v227
    v_pk_mul_f32 v[220:221], v[168:169], v[52:53]
    v_pk_mul_f32 v[222:223], v[184:185], v[52:53]
    v_pk_fma_f32 v[220:221], v[184:185], v[56:57], v[220:221]
    v_pk_fma_f32 v[222:223], v[168:169], v[56:57], v[222:223] neg_lo:[1,0,0] neg_hi:[1,0,0]
    v_pk_mul_f32 v[224:225], v[170:171], v[54:55]
    v_pk_mul_f32 v[226:227], v[186:187], v[54:55]
    v_pk_fma_f32 v[224:225], v[186:187], v[58:59], v[224:225]
    v_pk_fma_f32 v[226:227], v[170:171], v[58:59], v[226:227] neg_lo:[1,0,0] neg_hi:[1,0,0]
    v_cvt_pk_bf16_f32 v152, v220, v222
    v_cvt_pk_bf16_f32 v153, v221, v223
    v_cvt_pk_bf16_f32 v154, v224, v226
    v_cvt_pk_bf16_f32 v155, v225, v227
    s_nop 1
    v_mfma_f32_16x16x32_bf16 v[156:159], v[28:31], v[140:143], 0
    v_mfma_f32_16x16x32_bf16 v[172:175], v[32:35], v[140:143], 0
    v_mfma_f32_16x16x32_bf16 v[160:163], v[28:31], v[144:147], 0
    v_mfma_f32_16x16x32_bf16 v[176:179], v[32:35], v[144:147], 0
    v_mfma_f32_16x16x32_bf16 v[164:167], v[28:31], v[148:151], 0
    v_mfma_f32_16x16x32_bf16 v[180:183], v[32:35], v[148:151], 0
    v_mfma_f32_16x16x32_bf16 v[168:171], v[28:31], v[152:155], 0
    v_mfma_f32_16x16x32_bf16 v[184:187], v[32:35], v[152:155], 0
    s_barrier
    ds_read_b128 v[124:127], v228 offset:16384
    ds_read_b128 v[128:131], v228 offset:17408
    ds_read_b128 v[132:135], v228 offset:18432
    ds_read_b128 v[136:139], v228 offset:19456
    s_nop 7
    s_waitcnt lgkmcnt(0)
    v_lshlrev_b32 v188, 16, v124
    v_and_b32 v204, 0xffff0000, v124
    v_lshlrev_b32 v189, 16, v128
    v_and_b32 v205, 0xffff0000, v128
    v_lshlrev_b32 v190, 16, v132
    v_and_b32 v206, 0xffff0000, v132
    v_lshlrev_b32 v191, 16, v136
    v_and_b32 v207, 0xffff0000, v136
    v_lshlrev_b32 v192, 16, v125
    v_and_b32 v208, 0xffff0000, v125
    v_lshlrev_b32 v193, 16, v129
    v_and_b32 v209, 0xffff0000, v129
    v_lshlrev_b32 v194, 16, v133
    v_and_b32 v210, 0xffff0000, v133
    v_lshlrev_b32 v195, 16, v137
    v_and_b32 v211, 0xffff0000, v137
    v_lshlrev_b32 v196, 16, v126
    v_and_b32 v212, 0xffff0000, v126
    v_lshlrev_b32 v197, 16, v130
    v_and_b32 v213, 0xffff0000, v130
    v_lshlrev_b32 v198, 16, v134
    v_and_b32 v214, 0xffff0000, v134
    v_lshlrev_b32 v199, 16, v138
    v_and_b32 v215, 0xffff0000, v138
    v_lshlrev_b32 v200, 16, v127
    v_and_b32 v216, 0xffff0000, v127
    v_lshlrev_b32 v201, 16, v131
    v_and_b32 v217, 0xffff0000, v131
    v_lshlrev_b32 v202, 16, v135
    v_and_b32 v218, 0xffff0000, v135
    v_lshlrev_b32 v203, 16, v139
    v_and_b32 v219, 0xffff0000, v139
    v_pk_mul_f32 v[220:221], v[156:157], v[188:189]
    v_pk_mul_f32 v[222:223], v[172:173], v[188:189]
    v_pk_fma_f32 v[220:221], v[172:173], v[204:205], v[220:221] neg_lo:[1,0,0] neg_hi:[1,0,0]
    v_pk_fma_f32 v[222:223], v[156:157], v[204:205], v[222:223]
    v_pk_mul_f32 v[224:225], v[158:159], v[190:191]
    v_pk_mul_f32 v[226:227], v[174:175], v[190:191]
    v_pk_fma_f32 v[224:225], v[174:175], v[206:207], v[224:225] neg_lo:[1,0,0] neg_hi:[1,0,0]
    v_pk_fma_f32 v[226:227], v[158:159], v[206:207], v[226:227]
    v_cvt_pk_bf16_f32 v140, v220, v222
    v_cvt_pk_bf16_f32 v141, v221, v223
    v_cvt_pk_bf16_f32 v142, v224, v226
    v_cvt_pk_bf16_f32 v143, v225, v227
    v_pk_mul_f32 v[220:221], v[160:161], v[192:193]
    v_pk_mul_f32 v[222:223], v[176:177], v[192:193]
    v_pk_fma_f32 v[220:221], v[176:177], v[208:209], v[220:221] neg_lo:[1,0,0] neg_hi:[1,0,0]
    v_pk_fma_f32 v[222:223], v[160:161], v[208:209], v[222:223]
    v_pk_mul_f32 v[224:225], v[162:163], v[194:195]
    v_pk_mul_f32 v[226:227], v[178:179], v[194:195]
    v_pk_fma_f32 v[224:225], v[178:179], v[210:211], v[224:225] neg_lo:[1,0,0] neg_hi:[1,0,0]
    v_pk_fma_f32 v[226:227], v[162:163], v[210:211], v[226:227]
    v_cvt_pk_bf16_f32 v144, v220, v222
    v_cvt_pk_bf16_f32 v145, v221, v223
    v_cvt_pk_bf16_f32 v146, v224, v226
    v_cvt_pk_bf16_f32 v147, v225, v227
    v_pk_mul_f32 v[220:221], v[164:165], v[196:197]
    v_pk_mul_f32 v[222:223], v[180:181], v[196:197]
    v_pk_fma_f32 v[220:221], v[180:181], v[212:213], v[220:221] neg_lo:[1,0,0] neg_hi:[1,0,0]
    v_pk_fma_f32 v[222:223], v[164:165], v[212:213], v[222:223]
    v_pk_mul_f32 v[224:225], v[166:167], v[198:199]
    v_pk_mul_f32 v[226:227], v[182:183], v[198:199]
    v_pk_fma_f32 v[224:225], v[182:183], v[214:215], v[224:225] neg_lo:[1,0,0] neg_hi:[1,0,0]
    v_pk_fma_f32 v[226:227], v[166:167], v[214:215], v[226:227]
    v_cvt_pk_bf16_f32 v148, v220, v222
    v_cvt_pk_bf16_f32 v149, v221, v223
    v_cvt_pk_bf16_f32 v150, v224, v226
    v_cvt_pk_bf16_f32 v151, v225, v227
    v_pk_mul_f32 v[220:221], v[168:169], v[200:201]
    v_pk_mul_f32 v[222:223], v[184:185], v[200:201]
    v_pk_fma_f32 v[220:221], v[184:185], v[216:217], v[220:221] neg_lo:[1,0,0] neg_hi:[1,0,0]
    v_pk_fma_f32 v[222:223], v[168:169], v[216:217], v[222:223]
    v_pk_mul_f32 v[224:225], v[170:171], v[202:203]
    v_pk_mul_f32 v[226:227], v[186:187], v[202:203]
    v_pk_fma_f32 v[224:225], v[186:187], v[218:219], v[224:225] neg_lo:[1,0,0] neg_hi:[1,0,0]
    v_pk_fma_f32 v[226:227], v[170:171], v[218:219], v[226:227]
    v_cvt_pk_bf16_f32 v152, v220, v222
    v_cvt_pk_bf16_f32 v153, v221, v223
    v_cvt_pk_bf16_f32 v154, v224, v226
    v_cvt_pk_bf16_f32 v155, v225, v227
    s_nop 1
    v_mfma_f32_16x16x32_bf16 v[156:159], v[140:143], v[36:39], 0
    v_mfma_f32_16x16x32_bf16 v[172:175], v[140:143], v[40:43], 0
    v_mfma_f32_16x16x32_bf16 v[160:163], v[144:147], v[36:39], 0
    v_mfma_f32_16x16x32_bf16 v[176:179], v[144:147], v[40:43], 0
    v_mfma_f32_16x16x32_bf16 v[164:167], v[148:151], v[36:39], 0
    v_mfma_f32_16x16x32_bf16 v[180:183], v[148:151], v[40:43], 0
    v_mfma_f32_16x16x32_bf16 v[168:171], v[152:155], v[36:39], 0
    v_mfma_f32_16x16x32_bf16 v[184:187], v[152:155], v[40:43], 0
    s_nop 7
    v_pk_mul_f32 v[220:221], v[156:157], v[60:61]
    v_pk_mul_f32 v[222:223], v[172:173], v[60:61]
    v_pk_fma_f32 v[220:221], v[172:173], v[64:65], v[220:221] neg_lo:[1,0,0] neg_hi:[1,0,0]
    v_pk_fma_f32 v[222:223], v[156:157], v[64:65], v[222:223]
    v_pk_mul_f32 v[224:225], v[158:159], v[62:63]
    v_pk_mul_f32 v[226:227], v[174:175], v[62:63]
    v_pk_fma_f32 v[224:225], v[174:175], v[66:67], v[224:225] neg_lo:[1,0,0] neg_hi:[1,0,0]
    v_pk_fma_f32 v[226:227], v[158:159], v[66:67], v[226:227]
    v_cvt_pk_bf16_f32 v140, v220, v222
    v_cvt_pk_bf16_f32 v141, v221, v223
    v_cvt_pk_bf16_f32 v142, v224, v226
    v_cvt_pk_bf16_f32 v143, v225, v227
    v_pk_mul_f32 v[220:221], v[160:161], v[60:61]
    v_pk_mul_f32 v[222:223], v[176:177], v[60:61]
    v_pk_fma_f32 v[220:221], v[176:177], v[64:65], v[220:221] neg_lo:[1,0,0] neg_hi:[1,0,0]
    v_pk_fma_f32 v[222:223], v[160:161], v[64:65], v[222:223]
    v_pk_mul_f32 v[224:225], v[162:163], v[62:63]
    v_pk_mul_f32 v[226:227], v[178:179], v[62:63]
    v_pk_fma_f32 v[224:225], v[178:179], v[66:67], v[224:225] neg_lo:[1,0,0] neg_hi:[1,0,0]
    v_pk_fma_f32 v[226:227], v[162:163], v[66:67], v[226:227]
    v_cvt_pk_bf16_f32 v144, v220, v222
    v_cvt_pk_bf16_f32 v145, v221, v223
    v_cvt_pk_bf16_f32 v146, v224, v226
    v_cvt_pk_bf16_f32 v147, v225, v227
    v_pk_mul_f32 v[220:221], v[164:165], v[60:61]
    v_pk_mul_f32 v[222:223], v[180:181], v[60:61]
    v_pk_fma_f32 v[220:221], v[180:181], v[64:65], v[220:221] neg_lo:[1,0,0] neg_hi:[1,0,0]
    v_pk_fma_f32 v[222:223], v[164:165], v[64:65], v[222:223]
    v_pk_mul_f32 v[224:225], v[166:167], v[62:63]
    v_pk_mul_f32 v[226:227], v[182:183], v[62:63]
    v_pk_fma_f32 v[224:225], v[182:183], v[66:67], v[224:225] neg_lo:[1,0,0] neg_hi:[1,0,0]
    v_pk_fma_f32 v[226:227], v[166:167], v[66:67], v[226:227]
    v_cvt_pk_bf16_f32 v148, v220, v222
    v_cvt_pk_bf16_f32 v149, v221, v223
    v_cvt_pk_bf16_f32 v150, v224, v226
    v_cvt_pk_bf16_f32 v151, v225, v227
    v_pk_mul_f32 v[220:221], v[168:169], v[60:61]
    v_pk_mul_f32 v[222:223], v[184:185], v[60:61]
    v_pk_fma_f32 v[220:221], v[184:185], v[64:65], v[220:221] neg_lo:[1,0,0] neg_hi:[1,0,0]
    v_pk_fma_f32 v[222:223], v[168:169], v[64:65], v[222:223]
    v_pk_mul_f32 v[224:225], v[170:171], v[62:63]
    v_pk_mul_f32 v[226:227], v[186:187], v[62:63]
    v_pk_fma_f32 v[224:225], v[186:187], v[66:67], v[224:225] neg_lo:[1,0,0] neg_hi:[1,0,0]
    v_pk_fma_f32 v[226:227], v[170:171], v[66:67], v[226:227]
    v_cvt_pk_bf16_f32 v152, v220, v222
    v_cvt_pk_bf16_f32 v153, v221, v223
    v_cvt_pk_bf16_f32 v154, v224, v226
    v_cvt_pk_bf16_f32 v155, v225, v227
    s_nop 1
    v_mfma_f32_16x16x32_bf16 v[156:159], v[68:71], v[140:143], 0
    v_mfma_f32_16x16x32_bf16 v[172:175], v[72:75], v[140:143], 0
    v_mfma_f32_16x16x32_bf16 v[160:163], v[68:71], v[144:147], 0
    v_mfma_f32_16x16x32_bf16 v[176:179], v[72:75], v[144:147], 0
    v_mfma_f32_16x16x32_bf16 v[164:167], v[68:71], v[148:151], 0
    v_mfma_f32_16x16x32_bf16 v[180:183], v[72:75], v[148:151], 0
    v_mfma_f32_16x16x32_bf16 v[168:171], v[68:71], v[152:155], 0
    v_mfma_f32_16x16x32_bf16 v[184:187], v[72:75], v[152:155], 0
    s_nop 7
    v_cvt_pk_bf16_f32 v108, v156, v172
    v_cvt_pk_bf16_f32 v112, v157, v173
    v_cvt_pk_bf16_f32 v116, v158, v174
    v_cvt_pk_bf16_f32 v120, v159, v175
    v_cvt_pk_bf16_f32 v109, v160, v176
    v_cvt_pk_bf16_f32 v113, v161, v177
    v_cvt_pk_bf16_f32 v117, v162, v178
    v_cvt_pk_bf16_f32 v121, v163, v179
    v_cvt_pk_bf16_f32 v110, v164, v180
    v_cvt_pk_bf16_f32 v114, v165, v181
    v_cvt_pk_bf16_f32 v118, v166, v182
    v_cvt_pk_bf16_f32 v122, v167, v183
    v_cvt_pk_bf16_f32 v111, v168, v184
    v_cvt_pk_bf16_f32 v115, v169, v185
    v_cvt_pk_bf16_f32 v119, v170, v186
    v_cvt_pk_bf16_f32 v123, v171, v187
    ds_write_b128 v228, v[108:111] offset:0
    ds_write_b128 v228, v[112:115] offset:1024
    ds_write_b128 v228, v[116:119] offset:2048
    ds_write_b128 v228, v[120:123] offset:3072
    s_branch toG2_105
P2s0_102:
    s_mov_b32 s46, 0
    v_and_b32 v20, 15, v2
    v_lshrrev_b32 v21, 4, v2
    v_lshlrev_b32 v21, 2, v21
    v_lshlrev_b32 v22, 3, v20
    v_add_u32 v22, s46, v22
    s_mov_b32 s40, 1006632960
    s_mov_b32 s41, 973078528
    v_add_u32 v23, 0, v21
    v_mul_u32_u24 v24, v23, v22
    v_cvt_f32_u32 v25, v24
    v_mul_f32 v52, s41, v25
    v_and_b32 v24, 127, v24
    v_cvt_f32_u32 v24, v24
    v_mul_f32 v24, s40, v24
    v_cos_f32 v25, v24
    v_sin_f32 v26, v24
    v_sin_f32 v56, v52
    v_cos_f32 v52, v52
    v_cvt_pk_bf16_f32 v44, v25, v26
    v_cvt_pk_bf16_f32 v48, -v26, v25
    v_lshlrev_b32 v24, 3, v23
    v_add_u32 v24, s46, v24
    v_mul_u32_u24 v24, v24, v20
    v_cvt_f32_u32 v25, v24
    v_mul_f32 v60, s41, v25
    v_and_b32 v24, 127, v24
    v_cvt_f32_u32 v24, v24
    v_mul_f32 v24, s40, v24
    v_cos_f32 v25, v24
    v_sin_f32 v26, v24
    v_sin_f32 v64, v60
    v_cos_f32 v60, v60
    v_cvt_pk_bf16_f32 v68, v25, -v26
    v_cvt_pk_bf16_f32 v72, v26, v25
    v_add_u32 v23, 1, v21
    v_mul_u32_u24 v24, v23, v22
    v_cvt_f32_u32 v25, v24
    v_mul_f32 v53, s41, v25
    v_and_b32 v24, 127, v24
    v_cvt_f32_u32 v24, v24
    v_mul_f32 v24, s40, v24
    v_cos_f32 v25, v24
    v_sin_f32 v26, v24
    v_sin_f32 v57, v53
    v_cos_f32 v53, v53
    v_cvt_pk_bf16_f32 v45, v25, v26
    v_cvt_pk_bf16_f32 v49, -v26, v25
    v_lshlrev_b32 v24, 3, v23
    v_add_u32 v24, s46, v24
    v_mul_u32_u24 v24, v24, v20
    v_cvt_f32_u32 v25, v24
    v_mul_f32 v61, s41, v25
    v_and_b32 v24, 127, v24
    v_cvt_f32_u32 v24, v24
    v_mul_f32 v24, s40, v24
    v_cos_f32 v25, v24
    v_sin_f32 v26, v24
    v_sin_f32 v65, v61
    v_cos_f32 v61, v61
    v_cvt_pk_bf16_f32 v69, v25, -v26
    v_cvt_pk_bf16_f32 v73, v26, v25
    v_add_u32 v23, 2, v21
    v_mul_u32_u24 v24, v23, v22
    v_cvt_f32_u32 v25, v24
    v_mul_f32 v54, s41, v25
    v_and_b32 v24, 127, v24
    v_cvt_f32_u32 v24, v24
    v_mul_f32 v24, s40, v24
    v_cos_f32 v25, v24
    v_sin_f32 v26, v24
    v_sin_f32 v58, v54
    v_cos_f32 v54, v54
    v_cvt_pk_bf16_f32 v46, v25, v26
    v_cvt_pk_bf16_f32 v50, -v26, v25
    v_lshlrev_b32 v24, 3, v23
    v_add_u32 v24, s46, v24
    v_mul_u32_u24 v24, v24, v20
    v_cvt_f32_u32 v25, v24
    v_mul_f32 v62, s41, v25
    v_and_b32 v24, 127, v24
    v_cvt_f32_u32 v24, v24
    v_mul_f32 v24, s40, v24
    v_cos_f32 v25, v24
    v_sin_f32 v26, v24
    v_sin_f32 v66, v62
    v_cos_f32 v62, v62
    v_cvt_pk_bf16_f32 v70, v25, -v26
    v_cvt_pk_bf16_f32 v74, v26, v25
    v_add_u32 v23, 3, v21
    v_mul_u32_u24 v24, v23, v22
    v_cvt_f32_u32 v25, v24
    v_mul_f32 v55, s41, v25
    v_and_b32 v24, 127, v24
    v_cvt_f32_u32 v24, v24
    v_mul_f32 v24, s40, v24
    v_cos_f32 v25, v24
    v_sin_f32 v26, v24
    v_sin_f32 v59, v55
    v_cos_f32 v55, v55
    v_cvt_pk_bf16_f32 v47, v25, v26
    v_cvt_pk_bf16_f32 v51, -v26, v25
    v_lshlrev_b32 v24, 3, v23
    v_add_u32 v24, s46, v24
    v_mul_u32_u24 v24, v24, v20
    v_cvt_f32_u32 v25, v24
    v_mul_f32 v63, s41, v25
    v_and_b32 v24, 127, v24
    v_cvt_f32_u32 v24, v24
    v_mul_f32 v24, s40, v24
    v_cos_f32 v25, v24
    v_sin_f32 v26, v24
    v_sin_f32 v67, v63
    v_cos_f32 v63, v63
    v_cvt_pk_bf16_f32 v71, v25, -v26
    v_cvt_pk_bf16_f32 v75, v26, v25
    s_mov_b32 s46, 4
    v_and_b32 v20, 15, v2
    v_lshrrev_b32 v21, 4, v2
    v_lshlrev_b32 v21, 2, v21
    v_lshlrev_b32 v22, 3, v20
    v_add_u32 v22, s46, v22
    s_mov_b32 s40, 1006632960
    s_mov_b32 s41, 973078528
    v_add_u32 v23, 0, v21
    v_mul_u32_u24 v24, v23, v22
    v_cvt_f32_u32 v25, v24
    v_mul_f32 v84, s41, v25
    v_and_b32 v24, 127, v24
    v_cvt_f32_u32 v24, v24
    v_mul_f32 v24, s40, v24
    v_cos_f32 v25, v24
    v_sin_f32 v26, v24
    v_sin_f32 v88, v84
    v_cos_f32 v84, v84
    v_cvt_pk_bf16_f32 v76, v25, v26
    v_cvt_pk_bf16_f32 v80, -v26, v25
    v_lshlrev_b32 v24, 3, v23
    v_add_u32 v24, s46, v24
    v_mul_u32_u24 v24, v24, v20
    v_cvt_f32_u32 v25, v24
    v_mul_f32 v92, s41, v25
    v_and_b32 v24, 127, v24
    v_cvt_f32_u32 v24, v24
    v_mul_f32 v24, s40, v24
    v_cos_f32 v25, v24
    v_sin_f32 v26, v24
    v_sin_f32 v96, v92
    v_cos_f32 v92, v92
    v_cvt_pk_bf16_f32 v100, v25, -v26
    v_cvt_pk_bf16_f32 v104, v26, v25
    v_add_u32 v23, 1, v21
    v_mul_u32_u24 v24, v23, v22
    v_cvt_f32_u32 v25, v24
    v_mul_f32 v85, s41, v25
    v_and_b32 v24, 127, v24
    v_cvt_f32_u32 v24, v24
    v_mul_f32 v24, s40, v24
    v_cos_f32 v25, v24
    v_sin_f32 v26, v24
    v_sin_f32 v89, v85
    v_cos_f32 v85, v85
    v_cvt_pk_bf16_f32 v77, v25, v26
    v_cvt_pk_bf16_f32 v81, -v26, v25
    v_lshlrev_b32 v24, 3, v23
    v_add_u32 v24, s46, v24
    v_mul_u32_u24 v24, v24, v20
    v_cvt_f32_u32 v25, v24
    v_mul_f32 v93, s41, v25
    v_and_b32 v24, 127, v24
    v_cvt_f32_u32 v24, v24
    v_mul_f32 v24, s40, v24
    v_cos_f32 v25, v24
    v_sin_f32 v26, v24
    v_sin_f32 v97, v93
    v_cos_f32 v93, v93
    v_cvt_pk_bf16_f32 v101, v25, -v26
    v_cvt_pk_bf16_f32 v105, v26, v25
    v_add_u32 v23, 2, v21
    v_mul_u32_u24 v24, v23, v22
    v_cvt_f32_u32 v25, v24
    v_mul_f32 v86, s41, v25
    v_and_b32 v24, 127, v24
    v_cvt_f32_u32 v24, v24
    v_mul_f32 v24, s40, v24
    v_cos_f32 v25, v24
    v_sin_f32 v26, v24
    v_sin_f32 v90, v86
    v_cos_f32 v86, v86
    v_cvt_pk_bf16_f32 v78, v25, v26
    v_cvt_pk_bf16_f32 v82, -v26, v25
    v_lshlrev_b32 v24, 3, v23
    v_add_u32 v24, s46, v24
    v_mul_u32_u24 v24, v24, v20
    v_cvt_f32_u32 v25, v24
    v_mul_f32 v94, s41, v25
    v_and_b32 v24, 127, v24
    v_cvt_f32_u32 v24, v24
    v_mul_f32 v24, s40, v24
    v_cos_f32 v25, v24
    v_sin_f32 v26, v24
    v_sin_f32 v98, v94
    v_cos_f32 v94, v94
    v_cvt_pk_bf16_f32 v102, v25, -v26
    v_cvt_pk_bf16_f32 v106, v26, v25
    v_add_u32 v23, 3, v21
    v_mul_u32_u24 v24, v23, v22
    v_cvt_f32_u32 v25, v24
    v_mul_f32 v87, s41, v25
    v_and_b32 v24, 127, v24
    v_cvt_f32_u32 v24, v24
    v_mul_f32 v24, s40, v24
    v_cos_f32 v25, v24
    v_sin_f32 v26, v24
    v_sin_f32 v91, v87
    v_cos_f32 v87, v87
    v_cvt_pk_bf16_f32 v79, v25, v26
    v_cvt_pk_bf16_f32 v83, -v26, v25
    v_lshlrev_b32 v24, 3, v23
    v_add_u32 v24, s46, v24
    v_mul_u32_u24 v24, v24, v20
    v_cvt_f32_u32 v25, v24
    v_mul_f32 v95, s41, v25
    v_and_b32 v24, 127, v24
    v_cvt_f32_u32 v24, v24
    v_mul_f32 v24, s40, v24
    v_cos_f32 v25, v24
    v_sin_f32 v26, v24
    v_sin_f32 v99, v95
    v_cos_f32 v95, v95
    v_cvt_pk_bf16_f32 v103, v25, -v26
    v_cvt_pk_bf16_f32 v107, v26, v25
    v_and_b32 v20, 15, v2
    v_lshrrev_b32 v21, 4, v2
    v_lshl_add_u32 v21, v21, 6, v20
    v_lshlrev_b32 v21, 6, v21
    v_lshrrev_b32 v20, 2, v20
    s_lshr_b32 s40, s31, 1
    s_and_b32 s41, s31, 1
    s_lshl_b32 s41, s41, 3
    s_add_u32 s41, s41, 98304
    v_xor_b32 v22, s40, v20
    v_lshl_add_u32 v228, v22, 4, v21
    v_add_u32 v228, s41, v228
    v_xor_b32 v229, 32, v228
    s_cmp_eq_u32 s2, 255
    s_cselect_b32 s26, 1, 0
    s_cmp_eq_u32 s34, 1
    s_cbranch_scc0 X0s_106
    s_waitcnt vmcnt(0)
    s_barrier
X0s_106:
P2pass_103:
    s_barrier
    ds_read_b64 v[108:109], v228 offset:0
    ds_read_b64 v[110:111], v229 offset:0
    ds_read_b64 v[112:113], v228 offset:1024
    ds_read_b64 v[114:115], v229 offset:1024
    ds_read_b64 v[116:117], v228 offset:2048
    ds_read_b64 v[118:119], v229 offset:2048
    ds_read_b64 v[120:121], v228 offset:3072
    ds_read_b64 v[122:123], v229 offset:3072
    s_waitcnt lgkmcnt(0)
    v_lshlrev_b32 v220, 16, v108
    v_and_b32 v221, 0xffff0000, v108
    v_lshlrev_b32 v222, 16, v110
    v_and_b32 v223, 0xffff0000, v110
    v_add_f32 v224, v220, v222
    v_sub_f32 v225, v221, v223
    v_add_f32 v226, v221, v223
    v_sub_f32 v227, v222, v220
    v_mul_f32 v224, 0.5, v224
    v_mul_f32 v225, 0.5, v225
    v_mul_f32 v226, 0.5, v226
    v_mul_f32 v227, 0.5, v227
    v_cvt_pk_bf16_f32 v140, v224, v225
    v_cvt_pk_bf16_f32 v148, v226, v227
    v_lshlrev_b32 v220, 16, v112
    v_and_b32 v221, 0xffff0000, v112
    v_lshlrev_b32 v222, 16, v114
    v_and_b32 v223, 0xffff0000, v114
    v_add_f32 v224, v220, v222
    v_sub_f32 v225, v221, v223
    v_add_f32 v226, v221, v223
    v_sub_f32 v227, v222, v220
    v_mul_f32 v224, 0.5, v224
    v_mul_f32 v225, 0.5, v225
    v_mul_f32 v226, 0.5, v226
    v_mul_f32 v227, 0.5, v227
    v_cvt_pk_bf16_f32 v141, v224, v225
    v_cvt_pk_bf16_f32 v149, v226, v227
    v_lshlrev_b32 v220, 16, v116
    v_and_b32 v221, 0xffff0000, v116
    v_lshlrev_b32 v222, 16, v118
    v_and_b32 v223, 0xffff0000, v118
    v_add_f32 v224, v220, v222
    v_sub_f32 v225, v221, v223
    v_add_f32 v226, v221, v223
    v_sub_f32 v227, v222, v220
    v_mul_f32 v224, 0.5, v224
    v_mul_f32 v225, 0.5, v225
    v_mul_f32 v226, 0.5, v226
    v_mul_f32 v227, 0.5, v227
    v_cvt_pk_bf16_f32 v142, v224, v225
    v_cvt_pk_bf16_f32 v150, v226, v227
    v_lshlrev_b32 v220, 16, v120
    v_and_b32 v221, 0xffff0000, v120
    v_lshlrev_b32 v222, 16, v122
    v_and_b32 v223, 0xffff0000, v122
    v_add_f32 v224, v220, v222
    v_sub_f32 v225, v221, v223
    v_add_f32 v226, v221, v223
    v_sub_f32 v227, v222, v220
    v_mul_f32 v224, 0.5, v224
    v_mul_f32 v225, 0.5, v225
    v_mul_f32 v226, 0.5, v226
    v_mul_f32 v227, 0.5, v227
    v_cvt_pk_bf16_f32 v143, v224, v225
    v_cvt_pk_bf16_f32 v151, v226, v227
    v_lshlrev_b32 v220, 16, v109
    v_and_b32 v221, 0xffff0000, v109
    v_lshlrev_b32 v222, 16, v111
    v_and_b32 v223, 0xffff0000, v111
    v_add_f32 v224, v220, v222
    v_sub_f32 v225, v221, v223
    v_add_f32 v226, v221, v223
    v_sub_f32 v227, v222, v220
    v_mul_f32 v224, 0.5, v224
    v_mul_f32 v225, 0.5, v225
    v_mul_f32 v226, 0.5, v226
    v_mul_f32 v227, 0.5, v227
    v_cvt_pk_bf16_f32 v144, v224, v225
    v_cvt_pk_bf16_f32 v152, v226, v227
    v_lshlrev_b32 v220, 16, v113
    v_and_b32 v221, 0xffff0000, v113
    v_lshlrev_b32 v222, 16, v115
    v_and_b32 v223, 0xffff0000, v115
    v_add_f32 v224, v220, v222
    v_sub_f32 v225, v221, v223
    v_add_f32 v226, v221, v223
    v_sub_f32 v227, v222, v220
    v_mul_f32 v224, 0.5, v224
    v_mul_f32 v225, 0.5, v225
    v_mul_f32 v226, 0.5, v226
    v_mul_f32 v227, 0.5, v227
    v_cvt_pk_bf16_f32 v145, v224, v225
    v_cvt_pk_bf16_f32 v153, v226, v227
    v_lshlrev_b32 v220, 16, v117
    v_and_b32 v221, 0xffff0000, v117
    v_lshlrev_b32 v222, 16, v119
    v_and_b32 v223, 0xffff0000, v119
    v_add_f32 v224, v220, v222
    v_sub_f32 v225, v221, v223
    v_add_f32 v226, v221, v223
    v_sub_f32 v227, v222, v220
    v_mul_f32 v224, 0.5, v224
    v_mul_f32 v225, 0.5, v225
    v_mul_f32 v226, 0.5, v226
    v_mul_f32 v227, 0.5, v227
    v_cvt_pk_bf16_f32 v146, v224, v225
    v_cvt_pk_bf16_f32 v154, v226, v227
    v_lshlrev_b32 v220, 16, v121
    v_and_b32 v221, 0xffff0000, v121
    v_lshlrev_b32 v222, 16, v123
    v_and_b32 v223, 0xffff0000, v123
    v_add_f32 v224, v220, v222
    v_sub_f32 v225, v221, v223
    v_add_f32 v226, v221, v223
    v_sub_f32 v227, v222, v220
    v_mul_f32 v224, 0.5, v224
    v_mul_f32 v225, 0.5, v225
    v_mul_f32 v226, 0.5, v226
    v_mul_f32 v227, 0.5, v227
    v_cvt_pk_bf16_f32 v147, v224, v225
    v_cvt_pk_bf16_f32 v155, v226, v227
    s_nop 1
    v_mfma_f32_16x16x32_bf16 v[156:159], v[140:143], v[44:47], 0
    v_mfma_f32_16x16x32_bf16 v[172:175], v[140:143], v[48:51], 0
    v_mfma_f32_16x16x32_bf16 v[160:163], v[144:147], v[44:47], 0
    v_mfma_f32_16x16x32_bf16 v[176:179], v[144:147], v[48:51], 0
    v_mfma_f32_16x16x32_bf16 v[164:167], v[148:151], v[76:79], 0
    v_mfma_f32_16x16x32_bf16 v[180:183], v[148:151], v[80:83], 0
    v_mfma_f32_16x16x32_bf16 v[168:171], v[152:155], v[76:79], 0
    v_mfma_f32_16x16x32_bf16 v[184:187], v[152:155], v[80:83], 0
    s_nop 7
    v_pk_mul_f32 v[220:221], v[156:157], v[52:53]
    v_pk_mul_f32 v[222:223], v[172:173], v[52:53]
    v_pk_fma_f32 v[220:221], v[172:173], v[56:57], v[220:221]
    v_pk_fma_f32 v[222:223], v[156:157], v[56:57], v[222:223] neg_lo:[1,0,0] neg_hi:[1,0,0]
    v_pk_mul_f32 v[224:225], v[158:159], v[54:55]
    v_pk_mul_f32 v[226:227], v[174:175], v[54:55]
    v_pk_fma_f32 v[224:225], v[174:175], v[58:59], v[224:225]
    v_pk_fma_f32 v[226:227], v[158:159], v[58:59], v[226:227] neg_lo:[1,0,0] neg_hi:[1,0,0]
    v_cvt_pk_bf16_f32 v140, v220, v222
    v_cvt_pk_bf16_f32 v141, v221, v223
    v_cvt_pk_bf16_f32 v142, v224, v226
    v_cvt_pk_bf16_f32 v143, v225, v227
    v_pk_mul_f32 v[220:221], v[160:161], v[52:53]
    v_pk_mul_f32 v[222:223], v[176:177], v[52:53]
    v_pk_fma_f32 v[220:221], v[176:177], v[56:57], v[220:221]
    v_pk_fma_f32 v[222:223], v[160:161], v[56:57], v[222:223] neg_lo:[1,0,0] neg_hi:[1,0,0]
    v_pk_mul_f32 v[224:225], v[162:163], v[54:55]
    v_pk_mul_f32 v[226:227], v[178:179], v[54:55]
    v_pk_fma_f32 v[224:225], v[178:179], v[58:59], v[224:225]
    v_pk_fma_f32 v[226:227], v[162:163], v[58:59], v[226:227] neg_lo:[1,0,0] neg_hi:[1,0,0]
    v_cvt_pk_bf16_f32 v144, v220, v222
    v_cvt_pk_bf16_f32 v145, v221, v223
    v_cvt_pk_bf16_f32 v146, v224, v226
    v_cvt_pk_bf16_f32 v147, v225, v227
    v_pk_mul_f32 v[220:221], v[164:165], v[84:85]
    v_pk_mul_f32 v[222:223], v[180:181], v[84:85]
    v_pk_fma_f32 v[220:221], v[180:181], v[88:89], v[220:221]
    v_pk_fma_f32 v[222:223], v[164:165], v[88:89], v[222:223] neg_lo:[1,0,0] neg_hi:[1,0,0]
    v_pk_mul_f32 v[224:225], v[166:167], v[86:87]
    v_pk_mul_f32 v[226:227], v[182:183], v[86:87]
    v_pk_fma_f32 v[224:225], v[182:183], v[90:91], v[224:225]
    v_pk_fma_f32 v[226:227], v[166:167], v[90:91], v[226:227] neg_lo:[1,0,0] neg_hi:[1,0,0]
    v_cvt_pk_bf16_f32 v148, v220, v222
    v_cvt_pk_bf16_f32 v149, v221, v223
    v_cvt_pk_bf16_f32 v150, v224, v226
    v_cvt_pk_bf16_f32 v151, v225, v227
    v_pk_mul_f32 v[220:221], v[168:169], v[84:85]
    v_pk_mul_f32 v[222:223], v[184:185], v[84:85]
    v_pk_fma_f32 v[220:221], v[184:185], v[88:89], v[220:221]
    v_pk_fma_f32 v[222:223], v[168:169], v[88:89], v[222:223] neg_lo:[1,0,0] neg_hi:[1,0,0]
    v_pk_mul_f32 v[224:225], v[170:171], v[86:87]
    v_pk_mul_f32 v[226:227], v[186:187], v[86:87]
    v_pk_fma_f32 v[224:225], v[186:187], v[90:91], v[224:225]
    v_pk_fma_f32 v[226:227], v[170:171], v[90:91], v[226:227] neg_lo:[1,0,0] neg_hi:[1,0,0]
    v_cvt_pk_bf16_f32 v152, v220, v222
    v_cvt_pk_bf16_f32 v153, v221, v223
    v_cvt_pk_bf16_f32 v154, v224, v226
    v_cvt_pk_bf16_f32 v155, v225, v227
    s_nop 1
    v_mfma_f32_16x16x32_bf16 v[156:159], v[28:31], v[140:143], 0
    v_mfma_f32_16x16x32_bf16 v[172:175], v[32:35], v[140:143], 0
    v_mfma_f32_16x16x32_bf16 v[160:163], v[28:31], v[144:147], 0
    v_mfma_f32_16x16x32_bf16 v[176:179], v[32:35], v[144:147], 0
    v_mfma_f32_16x16x32_bf16 v[164:167], v[28:31], v[148:151], 0
    v_mfma_f32_16x16x32_bf16 v[180:183], v[32:35], v[148:151], 0
    v_mfma_f32_16x16x32_bf16 v[168:171], v[28:31], v[152:155], 0
    v_mfma_f32_16x16x32_bf16 v[184:187], v[32:35], v[152:155], 0
    s_barrier
    ds_read_b64 v[124:125], v228 offset:16384
    ds_read_b64 v[126:127], v229 offset:16384
    ds_read_b64 v[128:129], v228 offset:17408
    ds_read_b64 v[130:131], v229 offset:17408
    ds_read_b64 v[132:133], v228 offset:18432
    ds_read_b64 v[134:135], v229 offset:18432
    ds_read_b64 v[136:137], v228 offset:19456
    ds_read_b64 v[138:139], v229 offset:19456
    s_nop 7
    s_waitcnt lgkmcnt(0)
    v_lshlrev_b32 v188, 16, v124
    v_and_b32 v204, 0xffff0000, v124
    v_lshlrev_b32 v189, 16, v128
    v_and_b32 v205, 0xffff0000, v128
    v_lshlrev_b32 v190, 16, v132
    v_and_b32 v206, 0xffff0000, v132
    v_lshlrev_b32 v191, 16, v136
    v_and_b32 v207, 0xffff0000, v136
    v_lshlrev_b32 v192, 16, v125
    v_and_b32 v208, 0xffff0000, v125
    v_lshlrev_b32 v193, 16, v129
    v_and_b32 v209, 0xffff0000, v129
    v_lshlrev_b32 v194, 16, v133
    v_and_b32 v210, 0xffff0000, v133
    v_lshlrev_b32 v195, 16, v137
    v_and_b32 v211, 0xffff0000, v137
    v_lshlrev_b32 v196, 16, v126
    v_and_b32 v212, 0xffff0000, v126
    v_lshlrev_b32 v197, 16, v130
    v_and_b32 v213, 0xffff0000, v130
    v_lshlrev_b32 v198, 16, v134
    v_and_b32 v214, 0xffff0000, v134
    v_lshlrev_b32 v199, 16, v138
    v_and_b32 v215, 0xffff0000, v138
    v_lshlrev_b32 v200, 16, v127
    v_and_b32 v216, 0xffff0000, v127
    v_lshlrev_b32 v201, 16, v131
    v_and_b32 v217, 0xffff0000, v131
    v_lshlrev_b32 v202, 16, v135
    v_and_b32 v218, 0xffff0000, v135
    v_lshlrev_b32 v203, 16, v139
    v_and_b32 v219, 0xffff0000, v139
    v_pk_mul_f32 v[220:221], v[156:157], v[188:189]
    v_pk_mul_f32 v[222:223], v[172:173], v[188:189]
    v_pk_fma_f32 v[220:221], v[172:173], v[204:205], v[220:221] neg_lo:[1,0,0] neg_hi:[1,0,0]
    v_pk_fma_f32 v[222:223], v[156:157], v[204:205], v[222:223]
    v_pk_mul_f32 v[224:225], v[158:159], v[190:191]
    v_pk_mul_f32 v[226:227], v[174:175], v[190:191]
    v_pk_fma_f32 v[224:225], v[174:175], v[206:207], v[224:225] neg_lo:[1,0,0] neg_hi:[1,0,0]
    v_pk_fma_f32 v[226:227], v[158:159], v[206:207], v[226:227]
    v_cvt_pk_bf16_f32 v140, v220, v222
    v_cvt_pk_bf16_f32 v141, v221, v223
    v_cvt_pk_bf16_f32 v142, v224, v226
    v_cvt_pk_bf16_f32 v143, v225, v227
    v_pk_mul_f32 v[220:221], v[160:161], v[192:193]
    v_pk_mul_f32 v[222:223], v[176:177], v[192:193]
    v_pk_fma_f32 v[220:221], v[176:177], v[208:209], v[220:221] neg_lo:[1,0,0] neg_hi:[1,0,0]
    v_pk_fma_f32 v[222:223], v[160:161], v[208:209], v[222:223]
    v_pk_mul_f32 v[224:225], v[162:163], v[194:195]
    v_pk_mul_f32 v[226:227], v[178:179], v[194:195]
    v_pk_fma_f32 v[224:225], v[178:179], v[210:211], v[224:225] neg_lo:[1,0,0] neg_hi:[1,0,0]
    v_pk_fma_f32 v[226:227], v[162:163], v[210:211], v[226:227]
    v_cvt_pk_bf16_f32 v144, v220, v222
    v_cvt_pk_bf16_f32 v145, v221, v223
    v_cvt_pk_bf16_f32 v146, v224, v226
    v_cvt_pk_bf16_f32 v147, v225, v227
    v_pk_mul_f32 v[220:221], v[164:165], v[196:197]
    v_pk_mul_f32 v[222:223], v[180:181], v[196:197]
    v_pk_fma_f32 v[220:221], v[180:181], v[212:213], v[220:221] neg_lo:[1,0,0] neg_hi:[1,0,0]
    v_pk_fma_f32 v[222:223], v[164:165], v[212:213], v[222:223]
    v_pk_mul_f32 v[224:225], v[166:167], v[198:199]
    v_pk_mul_f32 v[226:227], v[182:183], v[198:199]
    v_pk_fma_f32 v[224:225], v[182:183], v[214:215], v[224:225] neg_lo:[1,0,0] neg_hi:[1,0,0]
    v_pk_fma_f32 v[226:227], v[166:167], v[214:215], v[226:227]
    v_cvt_pk_bf16_f32 v148, v220, v222
    v_cvt_pk_bf16_f32 v149, v221, v223
    v_cvt_pk_bf16_f32 v150, v224, v226
    v_cvt_pk_bf16_f32 v151, v225, v227
    v_pk_mul_f32 v[220:221], v[168:169], v[200:201]
    v_pk_mul_f32 v[222:223], v[184:185], v[200:201]
    v_pk_fma_f32 v[220:221], v[184:185], v[216:217], v[220:221] neg_lo:[1,0,0] neg_hi:[1,0,0]
    v_pk_fma_f32 v[222:223], v[168:169], v[216:217], v[222:223]
    v_pk_mul_f32 v[224:225], v[170:171], v[202:203]
    v_pk_mul_f32 v[226:227], v[186:187], v[202:203]
    v_pk_fma_f32 v[224:225], v[186:187], v[218:219], v[224:225] neg_lo:[1,0,0] neg_hi:[1,0,0]
    v_pk_fma_f32 v[226:227], v[170:171], v[218:219], v[226:227]
    v_cvt_pk_bf16_f32 v152, v220, v222
    v_cvt_pk_bf16_f32 v153, v221, v223
    v_cvt_pk_bf16_f32 v154, v224, v226
    v_cvt_pk_bf16_f32 v155, v225, v227
    s_nop 1
    v_mfma_f32_16x16x32_bf16 v[156:159], v[140:143], v[36:39], 0
    v_mfma_f32_16x16x32_bf16 v[172:175], v[140:143], v[40:43], 0
    v_mfma_f32_16x16x32_bf16 v[160:163], v[144:147], v[36:39], 0
    v_mfma_f32_16x16x32_bf16 v[176:179], v[144:147], v[40:43], 0
    v_mfma_f32_16x16x32_bf16 v[164:167], v[148:151], v[36:39], 0
    v_mfma_f32_16x16x32_bf16 v[180:183], v[148:151], v[40:43], 0
    v_mfma_f32_16x16x32_bf16 v[168:171], v[152:155], v[36:39], 0
    v_mfma_f32_16x16x32_bf16 v[184:187], v[152:155], v[40:43], 0
    s_nop 7
    v_pk_mul_f32 v[220:221], v[156:157], v[60:61]
    v_pk_mul_f32 v[222:223], v[172:173], v[60:61]
    v_pk_fma_f32 v[220:221], v[172:173], v[64:65], v[220:221] neg_lo:[1,0,0] neg_hi:[1,0,0]
    v_pk_fma_f32 v[222:223], v[156:157], v[64:65], v[222:223]
    v_pk_mul_f32 v[224:225], v[158:159], v[62:63]
    v_pk_mul_f32 v[226:227], v[174:175], v[62:63]
    v_pk_fma_f32 v[224:225], v[174:175], v[66:67], v[224:225] neg_lo:[1,0,0] neg_hi:[1,0,0]
    v_pk_fma_f32 v[226:227], v[158:159], v[66:67], v[226:227]
    v_cvt_pk_bf16_f32 v140, v220, v222
    v_cvt_pk_bf16_f32 v141, v221, v223
    v_cvt_pk_bf16_f32 v142, v224, v226
    v_cvt_pk_bf16_f32 v143, v225, v227
    v_pk_mul_f32 v[220:221], v[160:161], v[60:61]
    v_pk_mul_f32 v[222:223], v[176:177], v[60:61]
    v_pk_fma_f32 v[220:221], v[176:177], v[64:65], v[220:221] neg_lo:[1,0,0] neg_hi:[1,0,0]
    v_pk_fma_f32 v[222:223], v[160:161], v[64:65], v[222:223]
    v_pk_mul_f32 v[224:225], v[162:163], v[62:63]
    v_pk_mul_f32 v[226:227], v[178:179], v[62:63]
    v_pk_fma_f32 v[224:225], v[178:179], v[66:67], v[224:225] neg_lo:[1,0,0] neg_hi:[1,0,0]
    v_pk_fma_f32 v[226:227], v[162:163], v[66:67], v[226:227]
    v_cvt_pk_bf16_f32 v144, v220, v222
    v_cvt_pk_bf16_f32 v145, v221, v223
    v_cvt_pk_bf16_f32 v146, v224, v226
    v_cvt_pk_bf16_f32 v147, v225, v227
    v_pk_mul_f32 v[220:221], v[164:165], v[92:93]
    v_pk_mul_f32 v[222:223], v[180:181], v[92:93]
    v_pk_fma_f32 v[220:221], v[180:181], v[96:97], v[220:221] neg_lo:[1,0,0] neg_hi:[1,0,0]
    v_pk_fma_f32 v[222:223], v[164:165], v[96:97], v[222:223]
    v_pk_mul_f32 v[224:225], v[166:167], v[94:95]
    v_pk_mul_f32 v[226:227], v[182:183], v[94:95]
    v_pk_fma_f32 v[224:225], v[182:183], v[98:99], v[224:225] neg_lo:[1,0,0] neg_hi:[1,0,0]
    v_pk_fma_f32 v[226:227], v[166:167], v[98:99], v[226:227]
    v_cvt_pk_bf16_f32 v148, v220, v222
    v_cvt_pk_bf16_f32 v149, v221, v223
    v_cvt_pk_bf16_f32 v150, v224, v226
    v_cvt_pk_bf16_f32 v151, v225, v227
    v_pk_mul_f32 v[220:221], v[168:169], v[92:93]
    v_pk_mul_f32 v[222:223], v[184:185], v[92:93]
    v_pk_fma_f32 v[220:221], v[184:185], v[96:97], v[220:221] neg_lo:[1,0,0] neg_hi:[1,0,0]
    v_pk_fma_f32 v[222:223], v[168:169], v[96:97], v[222:223]
    v_pk_mul_f32 v[224:225], v[170:171], v[94:95]
    v_pk_mul_f32 v[226:227], v[186:187], v[94:95]
    v_pk_fma_f32 v[224:225], v[186:187], v[98:99], v[224:225] neg_lo:[1,0,0] neg_hi:[1,0,0]
    v_pk_fma_f32 v[226:227], v[170:171], v[98:99], v[226:227]
    v_cvt_pk_bf16_f32 v152, v220, v222
    v_cvt_pk_bf16_f32 v153, v221, v223
    v_cvt_pk_bf16_f32 v154, v224, v226
    v_cvt_pk_bf16_f32 v155, v225, v227
    s_nop 1
    v_mfma_f32_16x16x32_bf16 v[156:159], v[68:71], v[140:143], 0
    v_mfma_f32_16x16x32_bf16 v[172:175], v[72:75], v[140:143], 0
    v_mfma_f32_16x16x32_bf16 v[160:163], v[68:71], v[144:147], 0
    v_mfma_f32_16x16x32_bf16 v[176:179], v[72:75], v[144:147], 0
    v_mfma_f32_16x16x32_bf16 v[164:167], v[100:103], v[148:151], 0
    v_mfma_f32_16x16x32_bf16 v[180:183], v[104:107], v[148:151], 0
    v_mfma_f32_16x16x32_bf16 v[168:171], v[100:103], v[152:155], 0
    v_mfma_f32_16x16x32_bf16 v[184:187], v[104:107], v[152:155], 0
    s_nop 7
    v_sub_f32 v220, v156, v180
    v_add_f32 v221, v172, v164
    v_add_f32 v222, v156, v180
    v_sub_f32 v223, v164, v172
    v_cvt_pk_bf16_f32 v108, v220, v221
    v_cvt_pk_bf16_f32 v110, v222, v223
    v_sub_f32 v220, v157, v181
    v_add_f32 v221, v173, v165
    v_add_f32 v222, v157, v181
    v_sub_f32 v223, v165, v173
    v_cvt_pk_bf16_f32 v112, v220, v221
    v_cvt_pk_bf16_f32 v114, v222, v223
    v_sub_f32 v220, v158, v182
    v_add_f32 v221, v174, v166
    v_add_f32 v222, v158, v182
    v_sub_f32 v223, v166, v174
    v_cvt_pk_bf16_f32 v116, v220, v221
    v_cvt_pk_bf16_f32 v118, v222, v223
    v_sub_f32 v220, v159, v183
    v_add_f32 v221, v175, v167
    v_add_f32 v222, v159, v183
    v_sub_f32 v223, v167, v175
    v_cvt_pk_bf16_f32 v120, v220, v221
    v_cvt_pk_bf16_f32 v122, v222, v223
    v_sub_f32 v220, v160, v184
    v_add_f32 v221, v176, v168
    v_add_f32 v222, v160, v184
    v_sub_f32 v223, v168, v176
    v_cvt_pk_bf16_f32 v109, v220, v221
    v_cvt_pk_bf16_f32 v111, v222, v223
    v_sub_f32 v220, v161, v185
    v_add_f32 v221, v177, v169
    v_add_f32 v222, v161, v185
    v_sub_f32 v223, v169, v177
    v_cvt_pk_bf16_f32 v113, v220, v221
    v_cvt_pk_bf16_f32 v115, v222, v223
    v_sub_f32 v220, v162, v186
    v_add_f32 v221, v178, v170
    v_add_f32 v222, v162, v186
    v_sub_f32 v223, v170, v178
    v_cvt_pk_bf16_f32 v117, v220, v221
    v_cvt_pk_bf16_f32 v119, v222, v223
    v_sub_f32 v220, v163, v187
    v_add_f32 v221, v179, v171
    v_add_f32 v222, v163, v187
    v_sub_f32 v223, v171, v179
    v_cvt_pk_bf16_f32 v121, v220, v221
    v_cvt_pk_bf16_f32 v123, v222, v223
    ds_write_b64 v228, v[108:109] offset:0
    ds_write_b64 v229, v[110:111] offset:0
    ds_write_b64 v228, v[112:113] offset:1024
    ds_write_b64 v229, v[114:115] offset:1024
    ds_write_b64 v228, v[116:117] offset:2048
    ds_write_b64 v229, v[118:119] offset:2048
    ds_write_b64 v228, v[120:121] offset:3072
    ds_write_b64 v229, v[122:123] offset:3072
    s_cmp_eq_u32 s26, 1
    s_cbranch_scc0 toG2_105
    s_waitcnt lgkmcnt(0)
    s_barrier
    s_barrier
    s_mov_b32 s26, 0
    s_branch P2pass_103
toG2_105:
    s_waitcnt lgkmcnt(0)
    s_barrier
    s_lshr_b32 s25, s20, 2
    s_and_b32 s22, s20, 1
    s_lshl_b32 s22, s22, 3
    s_and_b32 s23, s21, 7
    s_add_u32 s22, s22, s23
    s_bfe_u32 s23, s20, 0x10001
    s_lshl_b32 s23, s23, 2
    s_lshr_b32 s24, s21, 3
    s_add_u32 s23, s23, s24
    s_add_u32 s32, s8, 33554432
    s_addc_u32 s33, s9, 0
    s_mov_b32 s34, 8388608
    s_mov_b32 s35, 0x20000
    s_and_b32 s40, s31, 1
    s_lshr_b32 s41, s31, 1
    v_and_b32 v4, 15, v2
    v_lshrrev_b32 v5, 4, v2
    s_mul_i32 s46, s40, 8192
    v_lshlrev_b32 v6, 4, v2
    v_add_u32 v12, s46, v6
    v_add_u32 v13, 1024, v12
    v_lshrrev_b32 v6, 2, v4
    v_and_b32 v7, 3, v4
    v_lshl_add_u32 v8, v5, 2, v6
    v_and_b32 v9, 7, v8
    v_lshlrev_b32 v8, 8, v8
    v_lshl_add_u32 v8, v7, 3, v8
    s_lshl_b32 s46, s41, 2
    s_add_u32 s47, s46, 0
    v_xor_b32 v10, s47, v9
    v_lshl_add_u32 v10, v10, 5, v8
    v_add_u32 v14, 16384, v10
    s_add_u32 s47, s46, 1
    v_xor_b32 v10, s47, v9
    v_lshl_add_u32 v10, v10, 5, v8
    v_add_u32 v15, 16384, v10
    s_add_u32 s47, s46, 2
    v_xor_b32 v10, s47, v9
    v_lshl_add_u32 v10, v10, 5, v8
    v_add_u32 v16, 16384, v10
    s_add_u32 s47, s46, 3
    v_xor_b32 v10, s47, v9
    v_lshl_add_u32 v10, v10, 5, v8
    v_add_u32 v17, 16384, v10
    v_mov_b32 v128, 0
    v_mov_b32 v129, 0
    v_mov_b32 v130, 0
    v_mov_b32 v131, 0
    v_mov_b32 v132, 0
    v_mov_b32 v133, 0
    v_mov_b32 v134, 0
    v_mov_b32 v135, 0
    v_mov_b32 v136, 0
    v_mov_b32 v137, 0
    v_mov_b32 v138, 0
    v_mov_b32 v139, 0
    v_mov_b32 v140, 0
    v_mov_b32 v141, 0
    v_mov_b32 v142, 0
    v_mov_b32 v143, 0
    v_mov_b32 v144, 0
    v_mov_b32 v145, 0
    v_mov_b32 v146, 0
    v_mov_b32 v147, 0
    v_mov_b32 v148, 0
    v_mov_b32 v149, 0
    v_mov_b32 v150, 0
    v_mov_b32 v151, 0
    v_mov_b32 v152, 0
    v_mov_b32 v153, 0
    v_mov_b32 v154, 0
    v_mov_b32 v155, 0
    v_mov_b32 v156, 0
    v_mov_b32 v157, 0
    v_mov_b32 v158, 0
    v_mov_b32 v159, 0
    v_mov_b32 v160, 0
    v_mov_b32 v161, 0
    v_mov_b32 v162, 0
    v_mov_b32 v163, 0
    v_mov_b32 v164, 0
    v_mov_b32 v165, 0
    v_mov_b32 v166, 0
    v_mov_b32 v167, 0
    v_mov_b32 v168, 0
    v_mov_b32 v169, 0
    v_mov_b32 v170, 0
    v_mov_b32 v171, 0
    v_mov_b32 v172, 0
    v_mov_b32 v173, 0
    v_mov_b32 v174, 0
    v_mov_b32 v175, 0
    v_mov_b32 v176, 0
    v_mov_b32 v177, 0
    v_mov_b32 v178, 0
    v_mov_b32 v179, 0
    v_mov_b32 v180, 0
    v_mov_b32 v181, 0
    v_mov_b32 v182, 0
    v_mov_b32 v183, 0
    v_mov_b32 v184, 0
    v_mov_b32 v185, 0
    v_mov_b32 v186, 0
    v_mov_b32 v187, 0
    v_mov_b32 v188, 0
    v_mov_b32 v189, 0
    v_mov_b32 v190, 0
    v_mov_b32 v191, 0
    s_mov_b32 s48, 0
    s_mov_b32 s49, 0
    s_mov_b32 s50, 32768
    s_mov_b32 s51, 4294901760
    s_barrier
    ds_read_b64_tr_b16 v[36:37], v14 offset:0
    ds_read_b64_tr_b16 v[38:39], v14 offset:4096
    ds_read_b128 v[20:23], v12 offset:0
    ds_read_b128 v[24:27], v12 offset:2048
    ds_read_b128 v[28:31], v12 offset:4096
    ds_read_b64_tr_b16 v[40:41], v15 offset:0
    ds_read_b128 v[32:35], v12 offset:6144
    ds_read_b64_tr_b16 v[42:43], v15 offset:4096
    ds_read_b64_tr_b16 v[44:45], v16 offset:0
    ds_read_b64_tr_b16 v[46:47], v16 offset:4096
    ds_read_b64_tr_b16 v[48:49], v17 offset:0
    ds_read_b64_tr_b16 v[50:51], v17 offset:4096
Lc_107:
    s_add_u32 s49, s49, 1
    s_cmp_eq_u32 s49, 3
    s_cselect_b32 s47, s51, s50
    s_cselect_b32 s49, 0, s49
    s_waitcnt lgkmcnt(0)
    v_mfma_f32_16x16x32_bf16 v[128:131], v[36:39], v[20:23], v[128:131]
    ds_read_b64_tr_b16 v[68:69], v14 offset:8192
    ds_read_b64_tr_b16 v[70:71], v14 offset:12288
    v_mfma_f32_16x16x32_bf16 v[144:147], v[36:39], v[24:27], v[144:147]
    ds_read_b128 v[52:55], v13 offset:0
    v_mfma_f32_16x16x32_bf16 v[160:163], v[36:39], v[28:31], v[160:163]
    ds_read_b128 v[56:59], v13 offset:2048
    v_mfma_f32_16x16x32_bf16 v[176:179], v[36:39], v[32:35], v[176:179]
    ds_read_b128 v[60:63], v13 offset:4096
    v_mfma_f32_16x16x32_bf16 v[132:135], v[40:43], v[20:23], v[132:135]
    ds_read_b64_tr_b16 v[72:73], v15 offset:8192
    v_mfma_f32_16x16x32_bf16 v[148:151], v[40:43], v[24:27], v[148:151]
    ds_read_b128 v[64:67], v13 offset:6144
    ds_read_b64_tr_b16 v[74:75], v15 offset:12288
    v_mfma_f32_16x16x32_bf16 v[164:167], v[40:43], v[28:31], v[164:167]
    ds_read_b64_tr_b16 v[76:77], v16 offset:8192
    v_mfma_f32_16x16x32_bf16 v[180:183], v[40:43], v[32:35], v[180:183]
    ds_read_b64_tr_b16 v[78:79], v16 offset:12288
    v_mfma_f32_16x16x32_bf16 v[136:139], v[44:47], v[20:23], v[136:139]
    ds_read_b64_tr_b16 v[80:81], v17 offset:8192
    v_mfma_f32_16x16x32_bf16 v[152:155], v[44:47], v[24:27], v[152:155]
    ds_read_b64_tr_b16 v[82:83], v17 offset:12288
    v_mfma_f32_16x16x32_bf16 v[168:171], v[44:47], v[28:31], v[168:171]
    v_add_u32 v12, s47, v12
    v_add_u32 v13, s47, v13
    v_mfma_f32_16x16x32_bf16 v[184:187], v[44:47], v[32:35], v[184:187]
    v_add_u32 v14, s47, v14
    v_mfma_f32_16x16x32_bf16 v[140:143], v[48:51], v[20:23], v[140:143]
    v_add_u32 v15, s47, v15
    v_mfma_f32_16x16x32_bf16 v[156:159], v[48:51], v[24:27], v[156:159]
    v_add_u32 v16, s47, v16
    v_mfma_f32_16x16x32_bf16 v[172:175], v[48:51], v[28:31], v[172:175]
    v_add_u32 v17, s47, v17
    v_mfma_f32_16x16x32_bf16 v[188:191], v[48:51], v[32:35], v[188:191]
    s_waitcnt lgkmcnt(0)
    s_barrier
    v_mfma_f32_16x16x32_bf16 v[128:131], v[68:71], v[52:55], v[128:131]
    ds_read_b64_tr_b16 v[36:37], v14 offset:0
    v_mfma_f32_16x16x32_bf16 v[144:147], v[68:71], v[56:59], v[144:147]
    ds_read_b64_tr_b16 v[38:39], v14 offset:4096
    v_mfma_f32_16x16x32_bf16 v[160:163], v[68:71], v[60:63], v[160:163]
    ds_read_b128 v[20:23], v12 offset:0
    v_mfma_f32_16x16x32_bf16 v[176:179], v[68:71], v[64:67], v[176:179]
    ds_read_b128 v[24:27], v12 offset:2048
    v_mfma_f32_16x16x32_bf16 v[132:135], v[72:75], v[52:55], v[132:135]
    v_mfma_f32_16x16x32_bf16 v[148:151], v[72:75], v[56:59], v[148:151]
    ds_read_b128 v[28:31], v12 offset:4096
    v_mfma_f32_16x16x32_bf16 v[164:167], v[72:75], v[60:63], v[164:167]
    ds_read_b64_tr_b16 v[40:41], v15 offset:0
    v_mfma_f32_16x16x32_bf16 v[180:183], v[72:75], v[64:67], v[180:183]
    ds_read_b128 v[32:35], v12 offset:6144
    v_mfma_f32_16x16x32_bf16 v[136:139], v[76:79], v[52:55], v[136:139]
    ds_read_b64_tr_b16 v[42:43], v15 offset:4096
    v_mfma_f32_16x16x32_bf16 v[152:155], v[76:79], v[56:59], v[152:155]
    v_mfma_f32_16x16x32_bf16 v[168:171], v[76:79], v[60:63], v[168:171]
    ds_read_b64_tr_b16 v[44:45], v16 offset:0
    v_mfma_f32_16x16x32_bf16 v[184:187], v[76:79], v[64:67], v[184:187]
    ds_read_b64_tr_b16 v[46:47], v16 offset:4096
    v_mfma_f32_16x16x32_bf16 v[140:143], v[80:83], v[52:55], v[140:143]
    ds_read_b64_tr_b16 v[48:49], v17 offset:0
    v_mfma_f32_16x16x32_bf16 v[156:159], v[80:83], v[56:59], v[156:159]
    ds_read_b64_tr_b16 v[50:51], v17 offset:4096
    v_mfma_f32_16x16x32_bf16 v[172:175], v[80:83], v[60:63], v[172:175]
    v_mfma_f32_16x16x32_bf16 v[188:191], v[80:83], v[64:67], v[188:191]
    s_add_u32 s48, s48, 1
    s_cmp_lt_u32 s48, 27
    s_cbranch_scc1 Lc_107
    s_waitcnt lgkmcnt(0)
    v_mfma_f32_16x16x32_bf16 v[128:131], v[36:39], v[20:23], v[128:131]
    ds_read_b64_tr_b16 v[68:69], v14 offset:8192
    v_mfma_f32_16x16x32_bf16 v[144:147], v[36:39], v[24:27], v[144:147]
    ds_read_b64_tr_b16 v[70:71], v14 offset:12288
    v_mfma_f32_16x16x32_bf16 v[160:163], v[36:39], v[28:31], v[160:163]
    ds_read_b128 v[52:55], v13 offset:0
    v_mfma_f32_16x16x32_bf16 v[176:179], v[36:39], v[32:35], v[176:179]
    ds_read_b128 v[56:59], v13 offset:2048
    v_mfma_f32_16x16x32_bf16 v[132:135], v[40:43], v[20:23], v[132:135]
    v_mfma_f32_16x16x32_bf16 v[148:151], v[40:43], v[24:27], v[148:151]
    ds_read_b128 v[60:63], v13 offset:4096
    v_mfma_f32_16x16x32_bf16 v[164:167], v[40:43], v[28:31], v[164:167]
    ds_read_b64_tr_b16 v[72:73], v15 offset:8192
    v_mfma_f32_16x16x32_bf16 v[180:183], v[40:43], v[32:35], v[180:183]
    ds_read_b128 v[64:67], v13 offset:6144
    v_mfma_f32_16x16x32_bf16 v[136:139], v[44:47], v[20:23], v[136:139]
    ds_read_b64_tr_b16 v[74:75], v15 offset:12288
    v_mfma_f32_16x16x32_bf16 v[152:155], v[44:47], v[24:27], v[152:155]
    v_mfma_f32_16x16x32_bf16 v[168:171], v[44:47], v[28:31], v[168:171]
    ds_read_b64_tr_b16 v[76:77], v16 offset:8192
    v_mfma_f32_16x16x32_bf16 v[184:187], v[44:47], v[32:35], v[184:187]
    ds_read_b64_tr_b16 v[78:79], v16 offset:12288
    v_mfma_f32_16x16x32_bf16 v[140:143], v[48:51], v[20:23], v[140:143]
    ds_read_b64_tr_b16 v[80:81], v17 offset:8192
    v_mfma_f32_16x16x32_bf16 v[156:159], v[48:51], v[24:27], v[156:159]
    ds_read_b64_tr_b16 v[82:83], v17 offset:12288
    v_mfma_f32_16x16x32_bf16 v[172:175], v[48:51], v[28:31], v[172:175]
    v_mfma_f32_16x16x32_bf16 v[188:191], v[48:51], v[32:35], v[188:191]
    s_waitcnt lgkmcnt(0)
    v_mfma_f32_16x16x32_bf16 v[128:131], v[68:71], v[52:55], v[128:131]
    v_mfma_f32_16x16x32_bf16 v[144:147], v[68:71], v[56:59], v[144:147]
    v_mfma_f32_16x16x32_bf16 v[160:163], v[68:71], v[60:63], v[160:163]
    v_mfma_f32_16x16x32_bf16 v[176:179], v[68:71], v[64:67], v[176:179]
    v_mfma_f32_16x16x32_bf16 v[132:135], v[72:75], v[52:55], v[132:135]
    v_mfma_f32_16x16x32_bf16 v[148:151], v[72:75], v[56:59], v[148:151]
    v_mfma_f32_16x16x32_bf16 v[164:167], v[72:75], v[60:63], v[164:167]
    v_mfma_f32_16x16x32_bf16 v[180:183], v[72:75], v[64:67], v[180:183]
    v_mfma_f32_16x16x32_bf16 v[136:139], v[76:79], v[52:55], v[136:139]
    v_mfma_f32_16x16x32_bf16 v[152:155], v[76:79], v[56:59], v[152:155]
    v_mfma_f32_16x16x32_bf16 v[168:171], v[76:79], v[60:63], v[168:171]
    v_mfma_f32_16x16x32_bf16 v[184:187], v[76:79], v[64:67], v[184:187]
    v_mfma_f32_16x16x32_bf16 v[140:143], v[80:83], v[52:55], v[140:143]
    v_mfma_f32_16x16x32_bf16 v[156:159], v[80:83], v[56:59], v[156:159]
    v_mfma_f32_16x16x32_bf16 v[172:175], v[80:83], v[60:63], v[172:175]
    v_mfma_f32_16x16x32_bf16 v[188:191], v[80:83], v[64:67], v[188:191]
    s_and_b32 s40, s31, 1
    s_lshr_b32 s41, s31, 1
    s_lshl_b32 s42, s25, 22
    s_lshl_b32 s43, s22, 18
    s_add_u32 s42, s42, s43
    s_lshl_b32 s43, s40, 17
    s_add_u32 s42, s42, s43
    s_lshl_b32 s43, s23, 12
    s_add_u32 s42, s42, s43
    s_lshl_b32 s43, s41, 11
    s_add_u32 s42, s42, s43
    v_and_b32 v4, 15, v2
    v_lshlrev_b32 v4, 6, v4
    v_lshrrev_b32 v5, 4, v2
    v_lshl_add_u32 v4, v5, 4, v4
    s_nop 7
    v_cvt_pk_bf16_f32 v20, v128, v129
    v_cvt_pk_bf16_f32 v21, v130, v131
    v_cvt_pk_bf16_f32 v22, v132, v133
    v_cvt_pk_bf16_f32 v23, v134, v135
    s_add_u32 s43, s42, 0
    buffer_store_dwordx4 v[20:23], v4, s[32:35], s43 offen sc1
    v_cvt_pk_bf16_f32 v24, v136, v137
    v_cvt_pk_bf16_f32 v25, v138, v139
    v_cvt_pk_bf16_f32 v26, v140, v141
    v_cvt_pk_bf16_f32 v27, v142, v143
    s_add_u32 s43, s42, 1024
    buffer_store_dwordx4 v[24:27], v4, s[32:35], s43 offen sc1
    v_cvt_pk_bf16_f32 v28, v144, v145
    v_cvt_pk_bf16_f32 v29, v146, v147
    v_cvt_pk_bf16_f32 v30, v148, v149
    v_cvt_pk_bf16_f32 v31, v150, v151
    s_add_u32 s43, s42, 32768
    buffer_store_dwordx4 v[28:31], v4, s[32:35], s43 offen sc1
    v_cvt_pk_bf16_f32 v32, v152, v153
    v_cvt_pk_bf16_f32 v33, v154, v155
    v_cvt_pk_bf16_f32 v34, v156, v157
    v_cvt_pk_bf16_f32 v35, v158, v159
    s_add_u32 s43, s42, 33792
    buffer_store_dwordx4 v[32:35], v4, s[32:35], s43 offen sc1
    v_cvt_pk_bf16_f32 v20, v160, v161
    v_cvt_pk_bf16_f32 v21, v162, v163
    v_cvt_pk_bf16_f32 v22, v164, v165
    v_cvt_pk_bf16_f32 v23, v166, v167
    s_add_u32 s43, s42, 65536
    buffer_store_dwordx4 v[20:23], v4, s[32:35], s43 offen sc1
    v_cvt_pk_bf16_f32 v24, v168, v169
    v_cvt_pk_bf16_f32 v25, v170, v171
    v_cvt_pk_bf16_f32 v26, v172, v173
    v_cvt_pk_bf16_f32 v27, v174, v175
    s_add_u32 s43, s42, 66560
    buffer_store_dwordx4 v[24:27], v4, s[32:35], s43 offen sc1
    v_cvt_pk_bf16_f32 v28, v176, v177
    v_cvt_pk_bf16_f32 v29, v178, v179
    v_cvt_pk_bf16_f32 v30, v180, v181
    v_cvt_pk_bf16_f32 v31, v182, v183
    s_add_u32 s43, s42, 98304
    buffer_store_dwordx4 v[28:31], v4, s[32:35], s43 offen sc1
    v_cvt_pk_bf16_f32 v32, v184, v185
    v_cvt_pk_bf16_f32 v33, v186, v187
    v_cvt_pk_bf16_f32 v34, v188, v189
    v_cvt_pk_bf16_f32 v35, v190, v191
    s_add_u32 s43, s42, 99328
    buffer_store_dwordx4 v[32:35], v4, s[32:35], s43 offen sc1
    s_lshl_b32 s60, s22, 4
    s_lshr_b32 s40, s20, 1
    s_lshl_b32 s40, s40, 2
    s_add_u32 s60, s60, s40
    s_lshr_b32 s40, s21, 3
    s_add_u32 s60, s60, s40
F_final:
    s_lshr_b32 s61, s31, 2
    s_load_dwordx2 s[6:7], s[0:1], 56
    s_add_u32 s16, s8, 50331648
    s_addc_u32 s17, s9, 0
    s_mov_b32 s18, 8192
    s_mov_b32 s19, 0x20000
    s_add_u32 s32, s8, 33554432
    s_addc_u32 s33, s9, 0
    s_mov_b32 s34, 8388608
    s_mov_b32 s35, 0x20000
    s_lshl_b32 s40, s61, 10
    s_add_u32 s40, s40, s60
    s_lshl_b32 s40, s40, 2
    v_mov_b32 v4, s40
    buffer_load_dword v80, v4, s[16:19], 0 offen offset:0 sc1
    buffer_load_dword v81, v4, s[16:19], 0 offen offset:1024 sc1
    buffer_load_dword v82, v4, s[16:19], 0 offen offset:2048 sc1
    buffer_load_dword v83, v4, s[16:19], 0 offen offset:3072 sc1
    s_waitcnt vmcnt(0) lgkmcnt(0)
    s_mov_b32 s24, s6
    s_mov_b32 s25, s7
    s_mov_b32 s26, 4194304
    s_mov_b32 s27, 0x20000
    s_barrier
    s_lshl_b32 s63, s22, 7
    s_cmp_eq_u32 s31, 4
    s_cbranch_scc0 Only_108
    v_mbcnt_lo_u32_b32 v24, -1, 0
    v_mbcnt_hi_u32_b32 v24, -1, v24
    v_lshlrev_b32 v24, 7, v24
    s_add_u32 s40, s63, 4096
    v_add_u32 v24, s40, v24
    v_mov_b32 v25, 1
    s_mov_b64 exec, 1
    buffer_atomic_add v25, v24, s[96:99], 0 offen sc0
    s_mov_b64 exec, -1
Only_108:
    v_sub_f32 v6, 1.0, v80
    v_cvt_pk_bf16_f32 v88, v6, 0
    v_cvt_pk_bf16_f32 v96, 0, v6
    v_sub_f32 v6, 1.0, v81
    v_cvt_pk_bf16_f32 v89, v6, 0
    v_cvt_pk_bf16_f32 v97, 0, v6
    v_sub_f32 v6, 1.0, v82
    v_cvt_pk_bf16_f32 v90, v6, 0
    v_cvt_pk_bf16_f32 v98, 0, v6
    v_sub_f32 v6, 1.0, v83
    v_cvt_pk_bf16_f32 v91, v6, 0
    v_cvt_pk_bf16_f32 v99, 0, v6
    v_and_b32 v4, 255, v0
    v_lshlrev_b32 v5, 4, v4
    v_add_u32 v5, 131072, v5
    ds_read_b128 v[112:115], v5 offset:0
    ds_read_b128 v[116:119], v5 offset:4096
    ds_read_b128 v[120:123], v5 offset:8192
    ds_read_b128 v[124:127], v5 offset:12288
    v_lshrrev_b32 v6, 3, v4
    v_lshlrev_b32 v6, 10, v6
    v_and_b32 v7, 3, v4
    v_lshl_add_u32 v6, v7, 4, v6
    v_bfe_u32 v7, v4, 2, 1
    v_lshl_add_u32 v22, v7, 3, v6
    v_lshlrev_b32 v23, 3, v4
    s_cmp_eq_u32 s61, 0
    s_cselect_b32 s50, 1.0, -1.0
    s_mov_b32 s51, s50
    s_mov_b32 s40, 1060439283
    s_mov_b32 s41, 3207922931
    s_cselect_b32 s52, s40, s41
    s_mov_b32 s53, s52
    s_waitcnt lgkmcnt(0)
    v_lshlrev_b32 v128, 16, v112
    v_and_b32 v130, 0xffff0000, v112
    v_lshlrev_b32 v129, 16, v113
    v_and_b32 v131, 0xffff0000, v113
    v_lshlrev_b32 v132, 16, v116
    v_and_b32 v134, 0xffff0000, v116
    v_lshlrev_b32 v133, 16, v117
    v_and_b32 v135, 0xffff0000, v117
    v_lshlrev_b32 v136, 16, v120
    v_and_b32 v138, 0xffff0000, v120
    v_lshlrev_b32 v137, 16, v121
    v_and_b32 v139, 0xffff0000, v121
    v_lshlrev_b32 v140, 16, v124
    v_and_b32 v142, 0xffff0000, v124
    v_lshlrev_b32 v141, 16, v125
    v_and_b32 v143, 0xffff0000, v125
    v_pk_add_f32 v[144:145], v[128:129], v[130:131]
    v_pk_add_f32 v[146:147], v[128:129], v[130:131] neg_lo:[0,1] neg_hi:[0,1]
    v_pk_add_f32 v[148:149], v[132:133], v[140:141] neg_lo:[0,1] neg_hi:[0,1]
    v_pk_add_f32 v[150:151], v[134:135], v[142:143]
    v_pk_add_f32 v[152:153], v[132:133], v[140:141]
    v_pk_add_f32 v[154:155], v[142:143], v[134:135] neg_lo:[0,1] neg_hi:[0,1]
    v_pk_add_f32 v[156:157], v[144:145], v[136:137]
    v_pk_fma_f32 v[176:177], v[152:153], s[50:51], v[156:157]
    v_pk_add_f32 v[156:157], v[144:145], v[136:137] neg_lo:[0,1] neg_hi:[0,1]
    v_pk_fma_f32 v[184:185], v[154:155], s[50:51], v[156:157]
    v_pk_add_f32 v[156:157], v[146:147], v[138:139] neg_lo:[0,1] neg_hi:[0,1]
    v_pk_add_f32 v[152:153], v[148:149], v[150:151] neg_lo:[0,1] neg_hi:[0,1]
    v_pk_fma_f32 v[180:181], v[152:153], s[52:53], v[156:157]
    v_pk_add_f32 v[156:157], v[146:147], v[138:139]
    v_pk_add_f32 v[154:155], v[148:149], v[150:151]
    v_pk_fma_f32 v[188:189], v[154:155], s[52:53], v[156:157] neg_lo:[1,0,0] neg_hi:[1,0,0]
    v_lshlrev_b32 v128, 16, v114
    v_and_b32 v130, 0xffff0000, v114
    v_lshlrev_b32 v129, 16, v115
    v_and_b32 v131, 0xffff0000, v115
    v_lshlrev_b32 v132, 16, v118
    v_and_b32 v134, 0xffff0000, v118
    v_lshlrev_b32 v133, 16, v119
    v_and_b32 v135, 0xffff0000, v119
    v_lshlrev_b32 v136, 16, v122
    v_and_b32 v138, 0xffff0000, v122
    v_lshlrev_b32 v137, 16, v123
    v_and_b32 v139, 0xffff0000, v123
    v_lshlrev_b32 v140, 16, v126
    v_and_b32 v142, 0xffff0000, v126
    v_lshlrev_b32 v141, 16, v127
    v_and_b32 v143, 0xffff0000, v127
    v_pk_add_f32 v[144:145], v[128:129], v[130:131]
    v_pk_add_f32 v[146:147], v[128:129], v[130:131] neg_lo:[0,1] neg_hi:[0,1]
    v_pk_add_f32 v[148:149], v[132:133], v[140:141] neg_lo:[0,1] neg_hi:[0,1]
    v_pk_add_f32 v[150:151], v[134:135], v[142:143]
    v_pk_add_f32 v[152:153], v[132:133], v[140:141]
    v_pk_add_f32 v[154:155], v[142:143], v[134:135] neg_lo:[0,1] neg_hi:[0,1]
    v_pk_add_f32 v[156:157], v[144:145], v[136:137]
    v_pk_fma_f32 v[178:179], v[152:153], s[50:51], v[156:157]
    v_pk_add_f32 v[156:157], v[144:145], v[136:137] neg_lo:[0,1] neg_hi:[0,1]
    v_pk_fma_f32 v[186:187], v[154:155], s[50:51], v[156:157]
    v_pk_add_f32 v[156:157], v[146:147], v[138:139] neg_lo:[0,1] neg_hi:[0,1]
    v_pk_add_f32 v[152:153], v[148:149], v[150:151] neg_lo:[0,1] neg_hi:[0,1]
    v_pk_fma_f32 v[182:183], v[152:153], s[52:53], v[156:157]
    v_pk_add_f32 v[156:157], v[146:147], v[138:139]
    v_pk_add_f32 v[154:155], v[148:149], v[150:151]
    v_pk_fma_f32 v[190:191], v[154:155], s[52:53], v[156:157] neg_lo:[1,0,0] neg_hi:[1,0,0]
    v_mul_f32 v176, v80, v176
    v_mul_f32 v177, v80, v177
    v_mul_f32 v178, v80, v178
    v_mul_f32 v179, v80, v179
    v_mul_f32 v180, v81, v180
    v_mul_f32 v181, v81, v181
    v_mul_f32 v182, v81, v182
    v_mul_f32 v183, v81, v183
    v_mul_f32 v184, v82, v184
    v_mul_f32 v185, v82, v185
    v_mul_f32 v186, v82, v186
    v_mul_f32 v187, v82, v187
    v_mul_f32 v188, v83, v188
    v_mul_f32 v189, v83, v189
    v_mul_f32 v190, v83, v190
    v_mul_f32 v191, v83, v191
    s_cmp_eq_u32 s31, 4
    s_cbranch_scc0 Only_109
    s_waitcnt vmcnt(0)
    v_readfirstlane_b32 s40, v25
    s_cmp_ge_u32 s40, 15
    s_cbranch_scc1 ep_110
    s_add_u32 s40, s63, 4096
    v_mov_b32 v4, s40
    s_mov_b32 s41, 0
Poll_111:
    buffer_load_dword v5, v4, s[96:99], 0 offen sc1
    s_waitcnt vmcnt(0)
    v_readfirstlane_b32 s40, v5
    s_add_u32 s41, s41, 1
    s_cmp_ge_u32 s40, 16
    s_cbranch_scc1 PollD_112
    s_cmp_ge_u32 s41, 100000
    s_cbranch_scc1 PollD_112
    s_branch Poll_111
PollD_112:
ep_110:
Only_109:
    s_barrier
    s_lshl_b32 s40, s22, 3
    s_lshl_b32 s41, s61, 2
    s_add_u32 s40, s40, s41
    s_lshl_b32 s40, s40, 15
    s_and_b32 s41, s60, 15
    s_lshl_b32 s41, s41, 6
    s_add_u32 s48, s40, s41
    s_add_u32 s47, s48, 0
    buffer_load_dwordx2 v[32:33], v22, s[32:35], s47 offen sc1
    s_add_u32 s47, s48, 4194304
    buffer_load_dwordx2 v[34:35], v22, s[32:35], s47 offen sc1
    s_add_u32 s47, s48, 32768
    buffer_load_dwordx2 v[36:37], v22, s[32:35], s47 offen sc1
    s_add_u32 s47, s48, 4227072
    buffer_load_dwordx2 v[38:39], v22, s[32:35], s47 offen sc1
    s_add_u32 s47, s48, 65536
    buffer_load_dwordx2 v[40:41], v22, s[32:35], s47 offen sc1
    s_add_u32 s47, s48, 4259840
    buffer_load_dwordx2 v[42:43], v22, s[32:35], s47 offen sc1
    s_add_u32 s47, s48, 98304
    buffer_load_dwordx2 v[44:45], v22, s[32:35], s47 offen sc1
    s_add_u32 s47, s48, 4292608
    buffer_load_dwordx2 v[46:47], v22, s[32:35], s47 offen sc1
    s_lshl_b32 s40, s61, 10
    s_add_u32 s40, s40, s60
    s_lshl_b32 s49, s40, 11
    s_waitcnt vmcnt(6)
    v_dot2_f32_bf16 v176, v32, v88, v176
    v_dot2_f32_bf16 v177, v32, v96, v177
    v_dot2_f32_bf16 v178, v33, v88, v178
    v_dot2_f32_bf16 v179, v33, v96, v179
    v_dot2_f32_bf16 v176, v34, v88, v176
    v_dot2_f32_bf16 v177, v34, v96, v177
    v_dot2_f32_bf16 v178, v35, v88, v178
    v_dot2_f32_bf16 v179, v35, v96, v179
    s_nop 2
    v_cvt_pk_bf16_f32 v128, v176, v177
    v_cvt_pk_bf16_f32 v129, v178, v179
    s_add_u32 s47, s49, 0
    buffer_store_dwordx2 v[128:129], v23, s[24:27], s47 offen
    s_waitcnt vmcnt(5)
    v_dot2_f32_bf16 v180, v36, v89, v180
    v_dot2_f32_bf16 v181, v36, v97, v181
    v_dot2_f32_bf16 v182, v37, v89, v182
    v_dot2_f32_bf16 v183, v37, v97, v183
    v_dot2_f32_bf16 v180, v38, v89, v180
    v_dot2_f32_bf16 v181, v38, v97, v181
    v_dot2_f32_bf16 v182, v39, v89, v182
    v_dot2_f32_bf16 v183, v39, v97, v183
    s_nop 2
    v_cvt_pk_bf16_f32 v130, v180, v181
    v_cvt_pk_bf16_f32 v131, v182, v183
    s_add_u32 s47, s49, 524288
    buffer_store_dwordx2 v[130:131], v23, s[24:27], s47 offen
    s_waitcnt vmcnt(4)
    v_dot2_f32_bf16 v184, v40, v90, v184
    v_dot2_f32_bf16 v185, v40, v98, v185
    v_dot2_f32_bf16 v186, v41, v90, v186
    v_dot2_f32_bf16 v187, v41, v98, v187
    v_dot2_f32_bf16 v184, v42, v90, v184
    v_dot2_f32_bf16 v185, v42, v98, v185
    v_dot2_f32_bf16 v186, v43, v90, v186
    v_dot2_f32_bf16 v187, v43, v98, v187
    s_nop 2
    v_cvt_pk_bf16_f32 v132, v184, v185
    v_cvt_pk_bf16_f32 v133, v186, v187
    s_add_u32 s47, s49, 1048576
    buffer_store_dwordx2 v[132:133], v23, s[24:27], s47 offen
    s_waitcnt vmcnt(3)
    v_dot2_f32_bf16 v188, v44, v91, v188
    v_dot2_f32_bf16 v189, v44, v99, v189
    v_dot2_f32_bf16 v190, v45, v91, v190
    v_dot2_f32_bf16 v191, v45, v99, v191
    v_dot2_f32_bf16 v188, v46, v91, v188
    v_dot2_f32_bf16 v189, v46, v99, v189
    v_dot2_f32_bf16 v190, v47, v91, v190
    v_dot2_f32_bf16 v191, v47, v99, v191
    s_nop 2
    v_cvt_pk_bf16_f32 v134, v188, v189
    v_cvt_pk_bf16_f32 v135, v190, v191
    s_add_u32 s47, s49, 1572864
    buffer_store_dwordx2 v[134:135], v23, s[24:27], s47 offen
F_end:
    s_endpgm
.p2align 8
TEXT_END:
.section .rodata,"a"
.p2align 6
.amdhsa_kernel gated_mix__spectral_gfnet__dense_activation_silu__prompt_kernel
.amdhsa_next_free_vgpr 256
.amdhsa_next_free_sgpr 102
.amdhsa_accum_offset 256
.amdhsa_group_segment_fixed_size 0
.amdhsa_kernarg_size 80
.amdhsa_user_sgpr_count 2
.amdhsa_user_sgpr_kernarg_segment_ptr 1
.amdhsa_system_sgpr_workgroup_id_x 1
.amdhsa_float_denorm_mode_32 3
.end_amdhsa_kernel
```
